```python
import torch

def _softmax(x, axis=-1):
    return torch.softmax(x, dim=axis)
def _gelu(x):
    return torch.nn.functional.gelu(x, approximate="tanh")
def _silu(x):
    return torch.nn.functional.silu(x)
def _sigmoid(x):
    return torch.sigmoid(x)
def _layernorm(x, axis=-1, eps=1e-5):
    m = x.mean(dim=axis, keepdim=True)
    v = x.var(dim=axis, keepdim=True, unbiased=False)
    return (x - m) / torch.sqrt(v + eps)
def _scatter_add(tgt, idx, src, axis=0):
    return tgt.clone().index_add_(axis, idx, src)
def _segment_sum(src, seg, n):
    out = torch.zeros((n,) + src.shape[1:], dtype=src.dtype)
    return out.index_add_(0, seg, src)
def _pad(x, pw):
    flat = tuple(v for pair in reversed(pw) for v in pair)
    return torch.nn.functional.pad(x, flat)

kernel_name = 'parallel_sum__spectral_fnet__dense_activation_squared_relu__prompt'

def setup_inputs():

    _w = (lambda a: (lambda t: t.to(torch.bfloat16) if t.is_floating_point() else t)(torch.as_tensor(a)))
    def _A_setup():
        B, S, D = 1, 2048, 512
        ns = torch.arange(S)[:, None] * torch.arange(S)[None, :]
        nd = torch.arange(D)[:, None] * torch.arange(D)[None, :]
        Ws_re = torch.cos(-2.0 * torch.pi * ns / S).to(float)
        Ws_im = torch.sin(-2.0 * torch.pi * ns / S).to(float)
        Wd_re = torch.cos(-2.0 * torch.pi * nd / D).to(float)
        Wd_im = torch.sin(-2.0 * torch.pi * nd / D).to(float)
        return {
            "x": _w((lambda *s: torch.randn(*s, dtype=torch.bfloat16) * 0.05)(B, S, D)),
            "dft_seq_re": _w(Ws_re),
            "dft_seq_im": _w(Ws_im),
            "dft_hid_re": _w(Wd_re),
            "dft_hid_im": _w(Wd_im),
        }
    _A_in = _A_setup()

    def _B_setup():
        B, S, D, F = 1, 2048, 512, 1792
        return {
            "x": _w((lambda *s: torch.randn(*s, dtype=torch.bfloat16) * 0.05)(B, S, D)),
            "w1": _w((lambda *s: torch.randn(*s, dtype=torch.bfloat16) * 0.2)(D, F)),
            "b1": _w((lambda *s: torch.randn(*s, dtype=torch.bfloat16) * 0.2)(F)),
            "w2": _w((lambda *s: torch.randn(*s, dtype=torch.bfloat16) * 0.2)(F, D)),
            "b2": _w((lambda *s: torch.randn(*s, dtype=torch.bfloat16) * 0.2)(D)),
        }
    _B_in = _B_setup()

    return {
        "A_x": _A_in["x"],
        "A_dft_seq_re": _A_in["dft_seq_re"],
        "A_dft_seq_im": _A_in["dft_seq_im"],
        "A_dft_hid_re": _A_in["dft_hid_re"],
        "A_dft_hid_im": _A_in["dft_hid_im"],
        "B_x": _B_in["x"],
        "B_w1": _B_in["w1"],
        "B_b1": _B_in["b1"],
        "B_w2": _B_in["w2"],
        "B_b2": _B_in["b2"],
    }

def reference(A_x, A_dft_seq_re, A_dft_seq_im, A_dft_hid_re, A_dft_hid_im, B_x, B_w1, B_b1, B_w2, B_b2):
    def _A_ref(x, dft_seq_re, dft_seq_im, dft_hid_re, dft_hid_im):
        a = torch.einsum("bsd,ed->bse", x, dft_hid_re)
        b = torch.einsum("bsd,ed->bse", x, dft_hid_im)
        y = torch.einsum("ts,bse->bte", dft_seq_re, a) - torch.einsum("ts,bse->bte", dft_seq_im, b)
        return y

    def _B_ref(x, w1, b1, w2, b2):
        h = torch.einsum("bsd,df->bsf", x, w1) + b1
        zero = torch.zeros_like(h)
        r = torch.where(h > zero, h, zero)
        h = r * r
        out = torch.einsum("bsf,fd->bsd", h, w2) + b2
        return out

    x = A_x
    xn = _layernorm(x, axis=-1)
    return x + _A_ref(xn, A_dft_seq_re, A_dft_seq_im, A_dft_hid_re, A_dft_hid_im) + _B_ref(xn, B_w1, B_b1, B_w2, B_b2)
```

```asm
; @launch kernel=gemm1_kernel grid=(256,1,1) block=(512,1,1) lds=137216
; @launch kernel=gemm2_kernel grid=(256,1,1) block=(512,1,1) lds=131072
.amdgcn_target "amdgcn-amd-amdhsa--gfx950"
.text
.globl gemm1_kernel
.p2align 8
.type gemm1_kernel,@function
gemm1_kernel:
    s_cmp_ge_u32 s2, 256
    s_cbranch_scc1 L_k1_end
    s_load_dwordx2 s[32:33], s[0:1], 96
    s_load_dwordx2 s[34:35], s[0:1], 24
    s_load_dwordx2 s[36:37], s[0:1], 32
    s_load_dwordx2 s[38:39], s[0:1], 48
    s_load_dwordx2 s[40:41], s[0:1], 56
    s_load_dwordx2 s[42:43], s[0:1], 64
    s_load_dwordx2 s[26:27], s[0:1], 8
    s_load_dwordx2 s[28:29], s[0:1], 16
    s_load_dwordx2 s[30:31], s[0:1], 0
    v_and_b32 v1, 63, v0
    v_lshrrev_b32 v2, 6, v0
    s_nop 0
    v_readfirstlane_b32 s16, v2
    s_lshr_b32 s53, s16, 2
    s_and_b32 s16, s16, 3
    s_lshr_b32 s44, s2, 4
    s_and_b32 s45, s2, 15
    s_lshl_b32 s46, s44, 7
    s_mov_b32 s17, 0
    s_mov_b32 s18, 8
    s_mov_b32 s19, 0
    s_and_b32 s49, s44, 7
    s_mov_b32 s51, 8
    s_waitcnt lgkmcnt(0)
    s_mov_b32 s4, s30
    s_and_b32 s5, s31, 0xffff
    s_mov_b32 s6, 2097152
    s_mov_b32 s7, 0x00020000
    s_cmp_ge_u32 s45, 8
    s_cbranch_scc1 L_k1_mlp
    s_cmp_lt_u32 s45, 4
    s_cselect_b64 s[24:25], s[34:35], s[36:37]
    s_mov_b32 s8, s24
    s_and_b32 s9, s25, 0xffff
    s_mov_b32 s10, 524288
    s_mov_b32 s11, 0x00020000
    s_and_b32 s47, s45, 3
    s_lshl_b32 s47, s47, 7
    s_mov_b32 s54, s18
    s_cmp_lg_u32 s53, 0
    s_cbranch_scc1 k1d_loader
    s_lshl_b32 s24, s44, 3
    s_add_u32 s24, s24, s45
    s_cmp_lt_u32 s24, 64
    s_cselect_b64 s[20:21], s[26:27], s[28:29]
    s_and_b32 s24, s24, 63
    s_lshl_b32 s24, s24, 17
    s_lshl_b32 s25, s16, 15
    s_add_u32 s58, s24, s25
    s_lshr_b32 s24, s16, 1
    s_and_b32 s25, s16, 1
    v_and_b32 v2, 15, v1
    v_lshrrev_b32 v3, 4, v1
    v_and_b32 v148, 7, v1
    v_xor_b32 v148, v148, v3
    v_lshlrev_b32 v148, 4, v148
    s_mul_i32 s12, s24, 8192
    v_lshl_add_u32 v149, v2, 7, v148
    v_add_u32 v149, s12, v149
    v_add_u32 v4, 0, v149
    v_xor_b32 v5, 64, v4
    v_add_u32 v8, 32768, v149
    v_xor_b32 v9, 64, v8
    v_add_u32 v12, 65536, v149
    v_xor_b32 v13, 64, v12
    v_add_u32 v16, 98304, v149
    v_xor_b32 v17, 64, v16
    s_mul_i32 s12, s25, 8192
    s_add_u32 s12, s12, 16384
    v_lshl_add_u32 v149, v2, 7, v148
    v_add_u32 v149, s12, v149
    v_add_u32 v6, 0, v149
    v_xor_b32 v7, 64, v6
    v_add_u32 v10, 32768, v149
    v_xor_b32 v11, 64, v10
    v_add_u32 v14, 65536, v149
    v_xor_b32 v15, 64, v14
    v_add_u32 v18, 98304, v149
    v_xor_b32 v19, 64, v18
    v_mov_b32 v84, 0
    v_mov_b32 v85, 0
    v_mov_b32 v86, 0
    v_mov_b32 v87, 0
    v_mov_b32 v88, 0
    v_mov_b32 v89, 0
    v_mov_b32 v90, 0
    v_mov_b32 v91, 0
    v_mov_b32 v92, 0
    v_mov_b32 v93, 0
    v_mov_b32 v94, 0
    v_mov_b32 v95, 0
    v_mov_b32 v96, 0
    v_mov_b32 v97, 0
    v_mov_b32 v98, 0
    v_mov_b32 v99, 0
    v_mov_b32 v100, 0
    v_mov_b32 v101, 0
    v_mov_b32 v102, 0
    v_mov_b32 v103, 0
    v_mov_b32 v104, 0
    v_mov_b32 v105, 0
    v_mov_b32 v106, 0
    v_mov_b32 v107, 0
    v_mov_b32 v108, 0
    v_mov_b32 v109, 0
    v_mov_b32 v110, 0
    v_mov_b32 v111, 0
    v_mov_b32 v112, 0
    v_mov_b32 v113, 0
    v_mov_b32 v114, 0
    v_mov_b32 v115, 0
    v_mov_b32 v116, 0
    v_mov_b32 v117, 0
    v_mov_b32 v118, 0
    v_mov_b32 v119, 0
    v_mov_b32 v120, 0
    v_mov_b32 v121, 0
    v_mov_b32 v122, 0
    v_mov_b32 v123, 0
    v_mov_b32 v124, 0
    v_mov_b32 v125, 0
    v_mov_b32 v126, 0
    v_mov_b32 v127, 0
    v_mov_b32 v128, 0
    v_mov_b32 v129, 0
    v_mov_b32 v130, 0
    v_mov_b32 v131, 0
    v_mov_b32 v132, 0
    v_mov_b32 v133, 0
    v_mov_b32 v134, 0
    v_mov_b32 v135, 0
    v_mov_b32 v136, 0
    v_mov_b32 v137, 0
    v_mov_b32 v138, 0
    v_mov_b32 v139, 0
    v_mov_b32 v140, 0
    v_mov_b32 v141, 0
    v_mov_b32 v142, 0
    v_mov_b32 v143, 0
    v_mov_b32 v144, 0
    v_mov_b32 v145, 0
    v_mov_b32 v146, 0
    v_mov_b32 v147, 0
    v_mov_b32 v156, 0
    v_mov_b32 v157, 0
    v_mov_b32 v158, 0
    v_mov_b32 v159, 0
    v_mov_b32 v160, 0
    v_mov_b32 v161, 0
    v_mov_b32 v162, 0
    v_mov_b32 v163, 0
    v_mov_b32 v164, 0
    v_mov_b32 v165, 0
    v_mov_b32 v166, 0
    v_mov_b32 v167, 0
    v_mov_b32 v168, 0
    v_mov_b32 v169, 0
    v_mov_b32 v170, 0
    v_mov_b32 v171, 0
    v_mov_b32 v172, 0x3f803f80
    v_mov_b32 v173, 0x3f803f80
    v_mov_b32 v174, 0x3f803f80
    v_mov_b32 v175, 0x3f803f80
    s_mov_b32 s12, s20
    s_and_b32 s13, s21, 0xffff
    s_mov_b32 s14, 8388608
    s_mov_b32 s15, 0x00020000
    v_lshlrev_b32 v180, 4, v1
    s_barrier
    buffer_load_dwordx4 v[176:179], v180, s[12:15], s58 offen
    buffer_load_dwordx4 v[176:179], v180, s[12:15], s58 offen offset:1024
    buffer_load_dwordx4 v[176:179], v180, s[12:15], s58 offen offset:2048
    buffer_load_dwordx4 v[176:179], v180, s[12:15], s58 offen offset:3072
    s_add_u32 s58, s58, 4096
    ds_read_b128 v[20:23], v4 offset:0
    ds_read_b128 v[24:27], v4 offset:2048
    ds_read_b128 v[28:31], v4 offset:4096
    ds_read_b128 v[32:35], v4 offset:6144
    ds_read_b128 v[52:55], v6 offset:0
    ds_read_b128 v[56:59], v6 offset:2048
    ds_read_b128 v[60:63], v6 offset:4096
    ds_read_b128 v[64:67], v6 offset:6144
    s_waitcnt lgkmcnt(0)
    v_mfma_f32_16x16x32_bf16 v[84:87], v[20:23], v[52:55], v[84:87]
    ds_read_b128 v[36:39], v5 offset:0
    v_mfma_f32_16x16x32_bf16 v[88:91], v[20:23], v[56:59], v[88:91]
    v_mfma_f32_16x16x32_bf16 v[92:95], v[20:23], v[60:63], v[92:95]
    ds_read_b128 v[40:43], v5 offset:2048
    v_mfma_f32_16x16x32_bf16 v[96:99], v[20:23], v[64:67], v[96:99]
    v_mfma_f32_16x16x32_bf16 v[100:103], v[24:27], v[52:55], v[100:103]
    ds_read_b128 v[44:47], v5 offset:4096
    v_mfma_f32_16x16x32_bf16 v[104:107], v[24:27], v[56:59], v[104:107]
    v_mfma_f32_16x16x32_bf16 v[108:111], v[24:27], v[60:63], v[108:111]
    ds_read_b128 v[48:51], v5 offset:6144
    v_mfma_f32_16x16x32_bf16 v[112:115], v[24:27], v[64:67], v[112:115]
    v_mfma_f32_16x16x32_bf16 v[116:119], v[28:31], v[52:55], v[116:119]
    ds_read_b128 v[68:71], v7 offset:0
    v_mfma_f32_16x16x32_bf16 v[120:123], v[28:31], v[56:59], v[120:123]
    v_mfma_f32_16x16x32_bf16 v[124:127], v[28:31], v[60:63], v[124:127]
    ds_read_b128 v[72:75], v7 offset:2048
    v_mfma_f32_16x16x32_bf16 v[128:131], v[28:31], v[64:67], v[128:131]
    v_mfma_f32_16x16x32_bf16 v[132:135], v[32:35], v[52:55], v[132:135]
    ds_read_b128 v[76:79], v7 offset:4096
    v_mfma_f32_16x16x32_bf16 v[136:139], v[32:35], v[56:59], v[136:139]
    v_mfma_f32_16x16x32_bf16 v[140:143], v[32:35], v[60:63], v[140:143]
    ds_read_b128 v[80:83], v7 offset:6144
    v_mfma_f32_16x16x32_bf16 v[144:147], v[32:35], v[64:67], v[144:147]
    v_mfma_f32_16x16x32_bf16 v[156:159], v[172:175], v[52:55], v[156:159]
    v_mfma_f32_16x16x32_bf16 v[160:163], v[172:175], v[56:59], v[160:163]
    v_mfma_f32_16x16x32_bf16 v[164:167], v[172:175], v[60:63], v[164:167]
    v_mfma_f32_16x16x32_bf16 v[168:171], v[172:175], v[64:67], v[168:171]
    s_waitcnt lgkmcnt(0)
    s_barrier
    s_sub_u32 s18, s18, 1
k1d_cloop:
    buffer_load_dwordx4 v[176:179], v180, s[12:15], s58 offen
    buffer_load_dwordx4 v[176:179], v180, s[12:15], s58 offen offset:1024
    buffer_load_dwordx4 v[176:179], v180, s[12:15], s58 offen offset:2048
    buffer_load_dwordx4 v[176:179], v180, s[12:15], s58 offen offset:3072
    s_add_u32 s58, s58, 4096
    v_mfma_f32_16x16x32_bf16 v[84:87], v[36:39], v[68:71], v[84:87]
    ds_read_b128 v[20:23], v8 offset:0
    v_mfma_f32_16x16x32_bf16 v[88:91], v[36:39], v[72:75], v[88:91]
    v_mfma_f32_16x16x32_bf16 v[92:95], v[36:39], v[76:79], v[92:95]
    ds_read_b128 v[24:27], v8 offset:2048
    v_mfma_f32_16x16x32_bf16 v[96:99], v[36:39], v[80:83], v[96:99]
    v_mfma_f32_16x16x32_bf16 v[100:103], v[40:43], v[68:71], v[100:103]
    ds_read_b128 v[28:31], v8 offset:4096
    v_mfma_f32_16x16x32_bf16 v[104:107], v[40:43], v[72:75], v[104:107]
    v_mfma_f32_16x16x32_bf16 v[108:111], v[40:43], v[76:79], v[108:111]
    ds_read_b128 v[32:35], v8 offset:6144
    v_mfma_f32_16x16x32_bf16 v[112:115], v[40:43], v[80:83], v[112:115]
    v_mfma_f32_16x16x32_bf16 v[116:119], v[44:47], v[68:71], v[116:119]
    ds_read_b128 v[52:55], v10 offset:0
    v_mfma_f32_16x16x32_bf16 v[120:123], v[44:47], v[72:75], v[120:123]
    v_mfma_f32_16x16x32_bf16 v[124:127], v[44:47], v[76:79], v[124:127]
    ds_read_b128 v[56:59], v10 offset:2048
    v_mfma_f32_16x16x32_bf16 v[128:131], v[44:47], v[80:83], v[128:131]
    v_mfma_f32_16x16x32_bf16 v[132:135], v[48:51], v[68:71], v[132:135]
    ds_read_b128 v[60:63], v10 offset:4096
    v_mfma_f32_16x16x32_bf16 v[136:139], v[48:51], v[72:75], v[136:139]
    v_mfma_f32_16x16x32_bf16 v[140:143], v[48:51], v[76:79], v[140:143]
    ds_read_b128 v[64:67], v10 offset:6144
    v_mfma_f32_16x16x32_bf16 v[144:147], v[48:51], v[80:83], v[144:147]
    v_mfma_f32_16x16x32_bf16 v[156:159], v[172:175], v[68:71], v[156:159]
    v_mfma_f32_16x16x32_bf16 v[160:163], v[172:175], v[72:75], v[160:163]
    v_mfma_f32_16x16x32_bf16 v[164:167], v[172:175], v[76:79], v[164:167]
    v_mfma_f32_16x16x32_bf16 v[168:171], v[172:175], v[80:83], v[168:171]
    s_waitcnt lgkmcnt(0)
    v_mfma_f32_16x16x32_bf16 v[84:87], v[20:23], v[52:55], v[84:87]
    ds_read_b128 v[36:39], v9 offset:0
    v_mfma_f32_16x16x32_bf16 v[88:91], v[20:23], v[56:59], v[88:91]
    v_mfma_f32_16x16x32_bf16 v[92:95], v[20:23], v[60:63], v[92:95]
    ds_read_b128 v[40:43], v9 offset:2048
    v_mfma_f32_16x16x32_bf16 v[96:99], v[20:23], v[64:67], v[96:99]
    v_mfma_f32_16x16x32_bf16 v[100:103], v[24:27], v[52:55], v[100:103]
    ds_read_b128 v[44:47], v9 offset:4096
    v_mfma_f32_16x16x32_bf16 v[104:107], v[24:27], v[56:59], v[104:107]
    v_mfma_f32_16x16x32_bf16 v[108:111], v[24:27], v[60:63], v[108:111]
    ds_read_b128 v[48:51], v9 offset:6144
    v_mfma_f32_16x16x32_bf16 v[112:115], v[24:27], v[64:67], v[112:115]
    v_mfma_f32_16x16x32_bf16 v[116:119], v[28:31], v[52:55], v[116:119]
    ds_read_b128 v[68:71], v11 offset:0
    v_mfma_f32_16x16x32_bf16 v[120:123], v[28:31], v[56:59], v[120:123]
    v_mfma_f32_16x16x32_bf16 v[124:127], v[28:31], v[60:63], v[124:127]
    ds_read_b128 v[72:75], v11 offset:2048
    v_mfma_f32_16x16x32_bf16 v[128:131], v[28:31], v[64:67], v[128:131]
    v_mfma_f32_16x16x32_bf16 v[132:135], v[32:35], v[52:55], v[132:135]
    ds_read_b128 v[76:79], v11 offset:4096
    v_mfma_f32_16x16x32_bf16 v[136:139], v[32:35], v[56:59], v[136:139]
    v_mfma_f32_16x16x32_bf16 v[140:143], v[32:35], v[60:63], v[140:143]
    ds_read_b128 v[80:83], v11 offset:6144
    v_mfma_f32_16x16x32_bf16 v[144:147], v[32:35], v[64:67], v[144:147]
    v_mfma_f32_16x16x32_bf16 v[156:159], v[172:175], v[52:55], v[156:159]
    v_mfma_f32_16x16x32_bf16 v[160:163], v[172:175], v[56:59], v[160:163]
    v_mfma_f32_16x16x32_bf16 v[164:167], v[172:175], v[60:63], v[164:167]
    v_mfma_f32_16x16x32_bf16 v[168:171], v[172:175], v[64:67], v[168:171]
    s_waitcnt lgkmcnt(0)
    s_barrier
    s_add_u32 s17, s17, 1
    s_cmp_ge_u32 s17, s18
    s_cbranch_scc1 k1d_cfin
    buffer_load_dwordx4 v[176:179], v180, s[12:15], s58 offen
    buffer_load_dwordx4 v[176:179], v180, s[12:15], s58 offen offset:1024
    buffer_load_dwordx4 v[176:179], v180, s[12:15], s58 offen offset:2048
    buffer_load_dwordx4 v[176:179], v180, s[12:15], s58 offen offset:3072
    s_add_u32 s58, s58, 4096
    v_mfma_f32_16x16x32_bf16 v[84:87], v[36:39], v[68:71], v[84:87]
    ds_read_b128 v[20:23], v12 offset:0
    v_mfma_f32_16x16x32_bf16 v[88:91], v[36:39], v[72:75], v[88:91]
    v_mfma_f32_16x16x32_bf16 v[92:95], v[36:39], v[76:79], v[92:95]
    ds_read_b128 v[24:27], v12 offset:2048
    v_mfma_f32_16x16x32_bf16 v[96:99], v[36:39], v[80:83], v[96:99]
    v_mfma_f32_16x16x32_bf16 v[100:103], v[40:43], v[68:71], v[100:103]
    ds_read_b128 v[28:31], v12 offset:4096
    v_mfma_f32_16x16x32_bf16 v[104:107], v[40:43], v[72:75], v[104:107]
    v_mfma_f32_16x16x32_bf16 v[108:111], v[40:43], v[76:79], v[108:111]
    ds_read_b128 v[32:35], v12 offset:6144
    v_mfma_f32_16x16x32_bf16 v[112:115], v[40:43], v[80:83], v[112:115]
    v_mfma_f32_16x16x32_bf16 v[116:119], v[44:47], v[68:71], v[116:119]
    ds_read_b128 v[52:55], v14 offset:0
    v_mfma_f32_16x16x32_bf16 v[120:123], v[44:47], v[72:75], v[120:123]
    v_mfma_f32_16x16x32_bf16 v[124:127], v[44:47], v[76:79], v[124:127]
    ds_read_b128 v[56:59], v14 offset:2048
    v_mfma_f32_16x16x32_bf16 v[128:131], v[44:47], v[80:83], v[128:131]
    v_mfma_f32_16x16x32_bf16 v[132:135], v[48:51], v[68:71], v[132:135]
    ds_read_b128 v[60:63], v14 offset:4096
    v_mfma_f32_16x16x32_bf16 v[136:139], v[48:51], v[72:75], v[136:139]
    v_mfma_f32_16x16x32_bf16 v[140:143], v[48:51], v[76:79], v[140:143]
    ds_read_b128 v[64:67], v14 offset:6144
    v_mfma_f32_16x16x32_bf16 v[144:147], v[48:51], v[80:83], v[144:147]
    v_mfma_f32_16x16x32_bf16 v[156:159], v[172:175], v[68:71], v[156:159]
    v_mfma_f32_16x16x32_bf16 v[160:163], v[172:175], v[72:75], v[160:163]
    v_mfma_f32_16x16x32_bf16 v[164:167], v[172:175], v[76:79], v[164:167]
    v_mfma_f32_16x16x32_bf16 v[168:171], v[172:175], v[80:83], v[168:171]
    s_waitcnt lgkmcnt(0)
    v_mfma_f32_16x16x32_bf16 v[84:87], v[20:23], v[52:55], v[84:87]
    ds_read_b128 v[36:39], v13 offset:0
    v_mfma_f32_16x16x32_bf16 v[88:91], v[20:23], v[56:59], v[88:91]
    v_mfma_f32_16x16x32_bf16 v[92:95], v[20:23], v[60:63], v[92:95]
    ds_read_b128 v[40:43], v13 offset:2048
    v_mfma_f32_16x16x32_bf16 v[96:99], v[20:23], v[64:67], v[96:99]
    v_mfma_f32_16x16x32_bf16 v[100:103], v[24:27], v[52:55], v[100:103]
    ds_read_b128 v[44:47], v13 offset:4096
    v_mfma_f32_16x16x32_bf16 v[104:107], v[24:27], v[56:59], v[104:107]
    v_mfma_f32_16x16x32_bf16 v[108:111], v[24:27], v[60:63], v[108:111]
    ds_read_b128 v[48:51], v13 offset:6144
    v_mfma_f32_16x16x32_bf16 v[112:115], v[24:27], v[64:67], v[112:115]
    v_mfma_f32_16x16x32_bf16 v[116:119], v[28:31], v[52:55], v[116:119]
    ds_read_b128 v[68:71], v15 offset:0
    v_mfma_f32_16x16x32_bf16 v[120:123], v[28:31], v[56:59], v[120:123]
    v_mfma_f32_16x16x32_bf16 v[124:127], v[28:31], v[60:63], v[124:127]
    ds_read_b128 v[72:75], v15 offset:2048
    v_mfma_f32_16x16x32_bf16 v[128:131], v[28:31], v[64:67], v[128:131]
    v_mfma_f32_16x16x32_bf16 v[132:135], v[32:35], v[52:55], v[132:135]
    ds_read_b128 v[76:79], v15 offset:4096
    v_mfma_f32_16x16x32_bf16 v[136:139], v[32:35], v[56:59], v[136:139]
    v_mfma_f32_16x16x32_bf16 v[140:143], v[32:35], v[60:63], v[140:143]
    ds_read_b128 v[80:83], v15 offset:6144
    v_mfma_f32_16x16x32_bf16 v[144:147], v[32:35], v[64:67], v[144:147]
    v_mfma_f32_16x16x32_bf16 v[156:159], v[172:175], v[52:55], v[156:159]
    v_mfma_f32_16x16x32_bf16 v[160:163], v[172:175], v[56:59], v[160:163]
    v_mfma_f32_16x16x32_bf16 v[164:167], v[172:175], v[60:63], v[164:167]
    v_mfma_f32_16x16x32_bf16 v[168:171], v[172:175], v[64:67], v[168:171]
    s_waitcnt lgkmcnt(0)
    s_barrier
    s_add_u32 s17, s17, 1
    s_cmp_ge_u32 s17, s18
    s_cbranch_scc1 k1d_cfin
    buffer_load_dwordx4 v[176:179], v180, s[12:15], s58 offen
    buffer_load_dwordx4 v[176:179], v180, s[12:15], s58 offen offset:1024
    buffer_load_dwordx4 v[176:179], v180, s[12:15], s58 offen offset:2048
    buffer_load_dwordx4 v[176:179], v180, s[12:15], s58 offen offset:3072
    s_add_u32 s58, s58, 4096
    v_mfma_f32_16x16x32_bf16 v[84:87], v[36:39], v[68:71], v[84:87]
    ds_read_b128 v[20:23], v16 offset:0
    v_mfma_f32_16x16x32_bf16 v[88:91], v[36:39], v[72:75], v[88:91]
    v_mfma_f32_16x16x32_bf16 v[92:95], v[36:39], v[76:79], v[92:95]
    ds_read_b128 v[24:27], v16 offset:2048
    v_mfma_f32_16x16x32_bf16 v[96:99], v[36:39], v[80:83], v[96:99]
    v_mfma_f32_16x16x32_bf16 v[100:103], v[40:43], v[68:71], v[100:103]
    ds_read_b128 v[28:31], v16 offset:4096
    v_mfma_f32_16x16x32_bf16 v[104:107], v[40:43], v[72:75], v[104:107]
    v_mfma_f32_16x16x32_bf16 v[108:111], v[40:43], v[76:79], v[108:111]
    ds_read_b128 v[32:35], v16 offset:6144
    v_mfma_f32_16x16x32_bf16 v[112:115], v[40:43], v[80:83], v[112:115]
    v_mfma_f32_16x16x32_bf16 v[116:119], v[44:47], v[68:71], v[116:119]
    ds_read_b128 v[52:55], v18 offset:0
    v_mfma_f32_16x16x32_bf16 v[120:123], v[44:47], v[72:75], v[120:123]
    v_mfma_f32_16x16x32_bf16 v[124:127], v[44:47], v[76:79], v[124:127]
    ds_read_b128 v[56:59], v18 offset:2048
    v_mfma_f32_16x16x32_bf16 v[128:131], v[44:47], v[80:83], v[128:131]
    v_mfma_f32_16x16x32_bf16 v[132:135], v[48:51], v[68:71], v[132:135]
    ds_read_b128 v[60:63], v18 offset:4096
    v_mfma_f32_16x16x32_bf16 v[136:139], v[48:51], v[72:75], v[136:139]
    v_mfma_f32_16x16x32_bf16 v[140:143], v[48:51], v[76:79], v[140:143]
    ds_read_b128 v[64:67], v18 offset:6144
    v_mfma_f32_16x16x32_bf16 v[144:147], v[48:51], v[80:83], v[144:147]
    v_mfma_f32_16x16x32_bf16 v[156:159], v[172:175], v[68:71], v[156:159]
    v_mfma_f32_16x16x32_bf16 v[160:163], v[172:175], v[72:75], v[160:163]
    v_mfma_f32_16x16x32_bf16 v[164:167], v[172:175], v[76:79], v[164:167]
    v_mfma_f32_16x16x32_bf16 v[168:171], v[172:175], v[80:83], v[168:171]
    s_waitcnt lgkmcnt(0)
    v_mfma_f32_16x16x32_bf16 v[84:87], v[20:23], v[52:55], v[84:87]
    ds_read_b128 v[36:39], v17 offset:0
    v_mfma_f32_16x16x32_bf16 v[88:91], v[20:23], v[56:59], v[88:91]
    v_mfma_f32_16x16x32_bf16 v[92:95], v[20:23], v[60:63], v[92:95]
    ds_read_b128 v[40:43], v17 offset:2048
    v_mfma_f32_16x16x32_bf16 v[96:99], v[20:23], v[64:67], v[96:99]
    v_mfma_f32_16x16x32_bf16 v[100:103], v[24:27], v[52:55], v[100:103]
    ds_read_b128 v[44:47], v17 offset:4096
    v_mfma_f32_16x16x32_bf16 v[104:107], v[24:27], v[56:59], v[104:107]
    v_mfma_f32_16x16x32_bf16 v[108:111], v[24:27], v[60:63], v[108:111]
    ds_read_b128 v[48:51], v17 offset:6144
    v_mfma_f32_16x16x32_bf16 v[112:115], v[24:27], v[64:67], v[112:115]
    v_mfma_f32_16x16x32_bf16 v[116:119], v[28:31], v[52:55], v[116:119]
    ds_read_b128 v[68:71], v19 offset:0
    v_mfma_f32_16x16x32_bf16 v[120:123], v[28:31], v[56:59], v[120:123]
    v_mfma_f32_16x16x32_bf16 v[124:127], v[28:31], v[60:63], v[124:127]
    ds_read_b128 v[72:75], v19 offset:2048
    v_mfma_f32_16x16x32_bf16 v[128:131], v[28:31], v[64:67], v[128:131]
    v_mfma_f32_16x16x32_bf16 v[132:135], v[32:35], v[52:55], v[132:135]
    ds_read_b128 v[76:79], v19 offset:4096
    v_mfma_f32_16x16x32_bf16 v[136:139], v[32:35], v[56:59], v[136:139]
    v_mfma_f32_16x16x32_bf16 v[140:143], v[32:35], v[60:63], v[140:143]
    ds_read_b128 v[80:83], v19 offset:6144
    v_mfma_f32_16x16x32_bf16 v[144:147], v[32:35], v[64:67], v[144:147]
    v_mfma_f32_16x16x32_bf16 v[156:159], v[172:175], v[52:55], v[156:159]
    v_mfma_f32_16x16x32_bf16 v[160:163], v[172:175], v[56:59], v[160:163]
    v_mfma_f32_16x16x32_bf16 v[164:167], v[172:175], v[60:63], v[164:167]
    v_mfma_f32_16x16x32_bf16 v[168:171], v[172:175], v[64:67], v[168:171]
    s_waitcnt lgkmcnt(0)
    s_barrier
    s_add_u32 s17, s17, 1
    s_cmp_ge_u32 s17, s18
    s_cbranch_scc1 k1d_cfin
    buffer_load_dwordx4 v[176:179], v180, s[12:15], s58 offen
    buffer_load_dwordx4 v[176:179], v180, s[12:15], s58 offen offset:1024
    buffer_load_dwordx4 v[176:179], v180, s[12:15], s58 offen offset:2048
    buffer_load_dwordx4 v[176:179], v180, s[12:15], s58 offen offset:3072
    s_add_u32 s58, s58, 4096
    v_mfma_f32_16x16x32_bf16 v[84:87], v[36:39], v[68:71], v[84:87]
    ds_read_b128 v[20:23], v4 offset:0
    v_mfma_f32_16x16x32_bf16 v[88:91], v[36:39], v[72:75], v[88:91]
    v_mfma_f32_16x16x32_bf16 v[92:95], v[36:39], v[76:79], v[92:95]
    ds_read_b128 v[24:27], v4 offset:2048
    v_mfma_f32_16x16x32_bf16 v[96:99], v[36:39], v[80:83], v[96:99]
    v_mfma_f32_16x16x32_bf16 v[100:103], v[40:43], v[68:71], v[100:103]
    ds_read_b128 v[28:31], v4 offset:4096
    v_mfma_f32_16x16x32_bf16 v[104:107], v[40:43], v[72:75], v[104:107]
    v_mfma_f32_16x16x32_bf16 v[108:111], v[40:43], v[76:79], v[108:111]
    ds_read_b128 v[32:35], v4 offset:6144
    v_mfma_f32_16x16x32_bf16 v[112:115], v[40:43], v[80:83], v[112:115]
    v_mfma_f32_16x16x32_bf16 v[116:119], v[44:47], v[68:71], v[116:119]
    ds_read_b128 v[52:55], v6 offset:0
    v_mfma_f32_16x16x32_bf16 v[120:123], v[44:47], v[72:75], v[120:123]
    v_mfma_f32_16x16x32_bf16 v[124:127], v[44:47], v[76:79], v[124:127]
    ds_read_b128 v[56:59], v6 offset:2048
    v_mfma_f32_16x16x32_bf16 v[128:131], v[44:47], v[80:83], v[128:131]
    v_mfma_f32_16x16x32_bf16 v[132:135], v[48:51], v[68:71], v[132:135]
    ds_read_b128 v[60:63], v6 offset:4096
    v_mfma_f32_16x16x32_bf16 v[136:139], v[48:51], v[72:75], v[136:139]
    v_mfma_f32_16x16x32_bf16 v[140:143], v[48:51], v[76:79], v[140:143]
    ds_read_b128 v[64:67], v6 offset:6144
    v_mfma_f32_16x16x32_bf16 v[144:147], v[48:51], v[80:83], v[144:147]
    v_mfma_f32_16x16x32_bf16 v[156:159], v[172:175], v[68:71], v[156:159]
    v_mfma_f32_16x16x32_bf16 v[160:163], v[172:175], v[72:75], v[160:163]
    v_mfma_f32_16x16x32_bf16 v[164:167], v[172:175], v[76:79], v[164:167]
    v_mfma_f32_16x16x32_bf16 v[168:171], v[172:175], v[80:83], v[168:171]
    s_waitcnt lgkmcnt(0)
    v_mfma_f32_16x16x32_bf16 v[84:87], v[20:23], v[52:55], v[84:87]
    ds_read_b128 v[36:39], v5 offset:0
    v_mfma_f32_16x16x32_bf16 v[88:91], v[20:23], v[56:59], v[88:91]
    v_mfma_f32_16x16x32_bf16 v[92:95], v[20:23], v[60:63], v[92:95]
    ds_read_b128 v[40:43], v5 offset:2048
    v_mfma_f32_16x16x32_bf16 v[96:99], v[20:23], v[64:67], v[96:99]
    v_mfma_f32_16x16x32_bf16 v[100:103], v[24:27], v[52:55], v[100:103]
    ds_read_b128 v[44:47], v5 offset:4096
    v_mfma_f32_16x16x32_bf16 v[104:107], v[24:27], v[56:59], v[104:107]
    v_mfma_f32_16x16x32_bf16 v[108:111], v[24:27], v[60:63], v[108:111]
    ds_read_b128 v[48:51], v5 offset:6144
    v_mfma_f32_16x16x32_bf16 v[112:115], v[24:27], v[64:67], v[112:115]
    v_mfma_f32_16x16x32_bf16 v[116:119], v[28:31], v[52:55], v[116:119]
    ds_read_b128 v[68:71], v7 offset:0
    v_mfma_f32_16x16x32_bf16 v[120:123], v[28:31], v[56:59], v[120:123]
    v_mfma_f32_16x16x32_bf16 v[124:127], v[28:31], v[60:63], v[124:127]
    ds_read_b128 v[72:75], v7 offset:2048
    v_mfma_f32_16x16x32_bf16 v[128:131], v[28:31], v[64:67], v[128:131]
    v_mfma_f32_16x16x32_bf16 v[132:135], v[32:35], v[52:55], v[132:135]
    ds_read_b128 v[76:79], v7 offset:4096
    v_mfma_f32_16x16x32_bf16 v[136:139], v[32:35], v[56:59], v[136:139]
    v_mfma_f32_16x16x32_bf16 v[140:143], v[32:35], v[60:63], v[140:143]
    ds_read_b128 v[80:83], v7 offset:6144
    v_mfma_f32_16x16x32_bf16 v[144:147], v[32:35], v[64:67], v[144:147]
    v_mfma_f32_16x16x32_bf16 v[156:159], v[172:175], v[52:55], v[156:159]
    v_mfma_f32_16x16x32_bf16 v[160:163], v[172:175], v[56:59], v[160:163]
    v_mfma_f32_16x16x32_bf16 v[164:167], v[172:175], v[60:63], v[164:167]
    v_mfma_f32_16x16x32_bf16 v[168:171], v[172:175], v[64:67], v[168:171]
    s_waitcnt lgkmcnt(0)
    s_barrier
    s_add_u32 s17, s17, 1
    s_cmp_ge_u32 s17, s18
    s_cbranch_scc1 k1d_cfin
    s_branch k1d_cloop
k1d_cfin:
    v_mfma_f32_16x16x32_bf16 v[84:87], v[36:39], v[68:71], v[84:87]
    v_mfma_f32_16x16x32_bf16 v[88:91], v[36:39], v[72:75], v[88:91]
    v_mfma_f32_16x16x32_bf16 v[92:95], v[36:39], v[76:79], v[92:95]
    v_mfma_f32_16x16x32_bf16 v[96:99], v[36:39], v[80:83], v[96:99]
    v_mfma_f32_16x16x32_bf16 v[100:103], v[40:43], v[68:71], v[100:103]
    v_mfma_f32_16x16x32_bf16 v[104:107], v[40:43], v[72:75], v[104:107]
    v_mfma_f32_16x16x32_bf16 v[108:111], v[40:43], v[76:79], v[108:111]
    v_mfma_f32_16x16x32_bf16 v[112:115], v[40:43], v[80:83], v[112:115]
    v_mfma_f32_16x16x32_bf16 v[116:119], v[44:47], v[68:71], v[116:119]
    v_mfma_f32_16x16x32_bf16 v[120:123], v[44:47], v[72:75], v[120:123]
    v_mfma_f32_16x16x32_bf16 v[124:127], v[44:47], v[76:79], v[124:127]
    v_mfma_f32_16x16x32_bf16 v[128:131], v[44:47], v[80:83], v[128:131]
    v_mfma_f32_16x16x32_bf16 v[132:135], v[48:51], v[68:71], v[132:135]
    v_mfma_f32_16x16x32_bf16 v[136:139], v[48:51], v[72:75], v[136:139]
    v_mfma_f32_16x16x32_bf16 v[140:143], v[48:51], v[76:79], v[140:143]
    v_mfma_f32_16x16x32_bf16 v[144:147], v[48:51], v[80:83], v[144:147]
    v_mfma_f32_16x16x32_bf16 v[156:159], v[172:175], v[68:71], v[156:159]
    v_mfma_f32_16x16x32_bf16 v[160:163], v[172:175], v[72:75], v[160:163]
    v_mfma_f32_16x16x32_bf16 v[164:167], v[172:175], v[76:79], v[164:167]
    v_mfma_f32_16x16x32_bf16 v[168:171], v[172:175], v[80:83], v[168:171]
    s_barrier
    s_nop 7
    s_nop 7
    s_branch k1d_cdone
k1d_loader:
    v_lshrrev_b32 v2, 3, v1
    v_and_b32 v3, 7, v1
    v_xor_b32 v3, v3, v2
    v_lshlrev_b32 v3, 4, v3
    s_mul_i32 s24, s16, 32
    s_add_u32 s24, s24, s46
    v_add_u32 v148, s24, v2
    s_mov_b32 s25, 1024
    v_mul_lo_u32 v148, v148, s25
    v_add_u32 v148, v148, v3
    v_add_u32 v4, 0, v148
    v_add_u32 v5, 7168, v148
    v_add_u32 v6, 14336, v148
    v_add_u32 v7, 21504, v148
    s_mul_i32 s24, s16, 32
    s_add_u32 s24, s24, s47
    v_add_u32 v148, s24, v2
    s_mov_b32 s25, 1024
    v_mul_lo_u32 v148, v148, s25
    v_add_u32 v148, v148, v3
    v_add_u32 v8, 0, v148
    v_add_u32 v9, 7168, v148
    v_add_u32 v10, 14336, v148
    v_add_u32 v11, 21504, v148
    s_mul_i32 s22, s16, 4096
    s_mul_i32 s23, s16, 4096
    s_add_u32 s23, s23, 16384
    v_lshrrev_b32 v2, 1, v1
    s_lshl_b32 s24, s16, 5
    v_add_u32 v2, s24, v2
    v_and_b32 v3, 1, v1
    v_lshlrev_b32 v3, 6, v3
    v_lshl_add_u32 v3, v2, 7, v3
    v_lshrrev_b32 v2, 1, v2
    v_add_u32 v40, 0, v2
    v_and_b32 v40, 3, v40
    v_lshl_add_u32 v32, v40, 4, v3
    v_add_u32 v40, 1, v2
    v_and_b32 v40, 3, v40
    v_lshl_add_u32 v33, v40, 4, v3
    v_add_u32 v40, 2, v2
    v_and_b32 v40, 3, v40
    v_lshl_add_u32 v34, v40, 4, v3
    v_add_u32 v40, 3, v2
    v_and_b32 v40, 3, v40
    v_lshl_add_u32 v35, v40, 4, v3
    v_mov_b32 v40, 0
    v_mov_b32 v41, 0
    v_mov_b32 v42, 0
    v_mov_b32 v43, 0
    v_mov_b32 v46, 0x3f803f80
    s_mov_b32 s55, 0
    s_mov_b32 s52, 0
    s_add_u32 s25, s19, s49
    s_cmp_ge_u32 s25, s54
    s_cselect_b32 s24, s51, 0
    s_sub_u32 s25, s25, s24
    s_lshl_b32 s20, s25, 7
    s_lshl_b32 s21, s25, 7
    s_add_u32 s19, s19, 1
    s_add_u32 s24, s22, s52
    s_add_u32 m0, s24, 0
    s_nop 0
    buffer_load_dwordx4 v4, s[4:7], s20 offen lds
    buffer_load_dwordx4 v5, s[4:7], s20 offen offset:1024 lds
    buffer_load_dwordx4 v6, s[4:7], s20 offen offset:2048 lds
    buffer_load_dwordx4 v7, s[4:7], s20 offen offset:3072 lds
    s_add_u32 s24, s23, s52
    s_add_u32 m0, s24, 0
    s_nop 0
    buffer_load_dwordx4 v8, s[8:11], s21 offen lds
    buffer_load_dwordx4 v9, s[8:11], s21 offen offset:1024 lds
    buffer_load_dwordx4 v10, s[8:11], s21 offen offset:2048 lds
    buffer_load_dwordx4 v11, s[8:11], s21 offen offset:3072 lds
    s_add_u32 s52, s52, 32768
    s_cmp_ge_u32 s52, 131072
    s_cselect_b32 s52, 0, s52
    s_add_u32 s25, s19, s49
    s_cmp_ge_u32 s25, s54
    s_cselect_b32 s24, s51, 0
    s_sub_u32 s25, s25, s24
    s_lshl_b32 s20, s25, 7
    s_lshl_b32 s21, s25, 7
    s_add_u32 s19, s19, 1
    s_add_u32 s24, s22, s52
    s_add_u32 m0, s24, 0
    s_nop 0
    buffer_load_dwordx4 v4, s[4:7], s20 offen lds
    buffer_load_dwordx4 v5, s[4:7], s20 offen offset:1024 lds
    buffer_load_dwordx4 v6, s[4:7], s20 offen offset:2048 lds
    buffer_load_dwordx4 v7, s[4:7], s20 offen offset:3072 lds
    s_add_u32 s24, s23, s52
    s_add_u32 m0, s24, 0
    s_nop 0
    buffer_load_dwordx4 v8, s[8:11], s21 offen lds
    buffer_load_dwordx4 v9, s[8:11], s21 offen offset:1024 lds
    buffer_load_dwordx4 v10, s[8:11], s21 offen offset:2048 lds
    buffer_load_dwordx4 v11, s[8:11], s21 offen offset:3072 lds
    s_add_u32 s52, s52, 32768
    s_cmp_ge_u32 s52, 131072
    s_cselect_b32 s52, 0, s52
    s_add_u32 s25, s19, s49
    s_cmp_ge_u32 s25, s54
    s_cselect_b32 s24, s51, 0
    s_sub_u32 s25, s25, s24
    s_lshl_b32 s20, s25, 7
    s_lshl_b32 s21, s25, 7
    s_add_u32 s19, s19, 1
    s_add_u32 s24, s22, s52
    s_add_u32 m0, s24, 0
    s_nop 0
    buffer_load_dwordx4 v4, s[4:7], s20 offen lds
    buffer_load_dwordx4 v5, s[4:7], s20 offen offset:1024 lds
    buffer_load_dwordx4 v6, s[4:7], s20 offen offset:2048 lds
    buffer_load_dwordx4 v7, s[4:7], s20 offen offset:3072 lds
    s_add_u32 s24, s23, s52
    s_add_u32 m0, s24, 0
    s_nop 0
    buffer_load_dwordx4 v8, s[8:11], s21 offen lds
    buffer_load_dwordx4 v9, s[8:11], s21 offen offset:1024 lds
    buffer_load_dwordx4 v10, s[8:11], s21 offen offset:2048 lds
    buffer_load_dwordx4 v11, s[8:11], s21 offen offset:3072 lds
    s_add_u32 s52, s52, 32768
    s_cmp_ge_u32 s52, 131072
    s_cselect_b32 s52, 0, s52
    s_add_u32 s25, s19, s49
    s_cmp_ge_u32 s25, s54
    s_cselect_b32 s24, s51, 0
    s_sub_u32 s25, s25, s24
    s_lshl_b32 s20, s25, 7
    s_lshl_b32 s21, s25, 7
    s_add_u32 s19, s19, 1
    s_add_u32 s24, s22, s52
    s_add_u32 m0, s24, 0
    s_nop 0
    buffer_load_dwordx4 v4, s[4:7], s20 offen lds
    buffer_load_dwordx4 v5, s[4:7], s20 offen offset:1024 lds
    buffer_load_dwordx4 v6, s[4:7], s20 offen offset:2048 lds
    buffer_load_dwordx4 v7, s[4:7], s20 offen offset:3072 lds
    s_add_u32 s24, s23, s52
    s_add_u32 m0, s24, 0
    s_nop 0
    buffer_load_dwordx4 v8, s[8:11], s21 offen lds
    buffer_load_dwordx4 v9, s[8:11], s21 offen offset:1024 lds
    buffer_load_dwordx4 v10, s[8:11], s21 offen offset:2048 lds
    buffer_load_dwordx4 v11, s[8:11], s21 offen offset:3072 lds
    s_add_u32 s52, s52, 32768
    s_cmp_ge_u32 s52, 131072
    s_cselect_b32 s52, 0, s52
    s_waitcnt vmcnt(24)
    s_barrier
    v_add_u32 v112, s55, v32
    ds_read_b128 v[64:67], v112
    v_add_u32 v113, s55, v33
    ds_read_b128 v[68:71], v113
    v_add_u32 v114, s55, v34
    ds_read_b128 v[72:75], v114
    v_add_u32 v115, s55, v35
    ds_read_b128 v[76:79], v115
    s_waitcnt lgkmcnt(3)
    v_dot2_f32_bf16 v40, v64, v46, v40
    v_dot2_f32_bf16 v42, v64, v64, v42
    v_dot2_f32_bf16 v41, v65, v46, v41
    v_dot2_f32_bf16 v43, v65, v65, v43
    v_dot2_f32_bf16 v40, v66, v46, v40
    v_dot2_f32_bf16 v42, v66, v66, v42
    v_dot2_f32_bf16 v41, v67, v46, v41
    v_dot2_f32_bf16 v43, v67, v67, v43
    s_waitcnt lgkmcnt(2)
    v_dot2_f32_bf16 v40, v68, v46, v40
    v_dot2_f32_bf16 v42, v68, v68, v42
    v_dot2_f32_bf16 v41, v69, v46, v41
    v_dot2_f32_bf16 v43, v69, v69, v43
    v_dot2_f32_bf16 v40, v70, v46, v40
    v_dot2_f32_bf16 v42, v70, v70, v42
    v_dot2_f32_bf16 v41, v71, v46, v41
    v_dot2_f32_bf16 v43, v71, v71, v43
    s_waitcnt lgkmcnt(1)
    v_dot2_f32_bf16 v40, v72, v46, v40
    v_dot2_f32_bf16 v42, v72, v72, v42
    v_dot2_f32_bf16 v41, v73, v46, v41
    v_dot2_f32_bf16 v43, v73, v73, v43
    v_dot2_f32_bf16 v40, v74, v46, v40
    v_dot2_f32_bf16 v42, v74, v74, v42
    v_dot2_f32_bf16 v41, v75, v46, v41
    v_dot2_f32_bf16 v43, v75, v75, v43
    s_waitcnt lgkmcnt(0)
    v_dot2_f32_bf16 v40, v76, v46, v40
    v_dot2_f32_bf16 v42, v76, v76, v42
    v_dot2_f32_bf16 v41, v77, v46, v41
    v_dot2_f32_bf16 v43, v77, v77, v43
    v_dot2_f32_bf16 v40, v78, v46, v40
    v_dot2_f32_bf16 v42, v78, v78, v42
    v_dot2_f32_bf16 v41, v79, v46, v41
    v_dot2_f32_bf16 v43, v79, v79, v43
    s_add_u32 s55, s55, 32768
    s_cmp_ge_u32 s55, 131072
    s_cselect_b32 s55, 0, s55
    s_waitcnt vmcnt(16)
    s_barrier
    s_sub_u32 s50, s18, 1
k1d_lloop:
    s_cmp_ge_u32 s19, s18
    s_cbranch_scc1 k1d_lnd
    s_add_u32 s25, s19, s49
    s_cmp_ge_u32 s25, s54
    s_cselect_b32 s24, s51, 0
    s_sub_u32 s25, s25, s24
    s_lshl_b32 s20, s25, 7
    s_lshl_b32 s21, s25, 7
    s_add_u32 s19, s19, 1
    s_add_u32 s24, s22, s52
    s_add_u32 m0, s24, 0
    s_nop 0
    buffer_load_dwordx4 v4, s[4:7], s20 offen lds
    buffer_load_dwordx4 v5, s[4:7], s20 offen offset:1024 lds
    buffer_load_dwordx4 v6, s[4:7], s20 offen offset:2048 lds
    buffer_load_dwordx4 v7, s[4:7], s20 offen offset:3072 lds
    s_add_u32 s24, s23, s52
    s_add_u32 m0, s24, 0
    s_nop 0
    buffer_load_dwordx4 v8, s[8:11], s21 offen lds
    buffer_load_dwordx4 v9, s[8:11], s21 offen offset:1024 lds
    buffer_load_dwordx4 v10, s[8:11], s21 offen offset:2048 lds
    buffer_load_dwordx4 v11, s[8:11], s21 offen offset:3072 lds
    s_add_u32 s52, s52, 32768
    s_cmp_ge_u32 s52, 131072
    s_cselect_b32 s52, 0, s52
    v_add_u32 v112, s55, v32
    ds_read_b128 v[64:67], v112
    v_add_u32 v113, s55, v33
    ds_read_b128 v[68:71], v113
    v_add_u32 v114, s55, v34
    ds_read_b128 v[72:75], v114
    v_add_u32 v115, s55, v35
    ds_read_b128 v[76:79], v115
    s_waitcnt lgkmcnt(3)
    v_dot2_f32_bf16 v40, v64, v46, v40
    v_dot2_f32_bf16 v42, v64, v64, v42
    v_dot2_f32_bf16 v41, v65, v46, v41
    v_dot2_f32_bf16 v43, v65, v65, v43
    v_dot2_f32_bf16 v40, v66, v46, v40
    v_dot2_f32_bf16 v42, v66, v66, v42
    v_dot2_f32_bf16 v41, v67, v46, v41
    v_dot2_f32_bf16 v43, v67, v67, v43
    s_waitcnt lgkmcnt(2)
    v_dot2_f32_bf16 v40, v68, v46, v40
    v_dot2_f32_bf16 v42, v68, v68, v42
    v_dot2_f32_bf16 v41, v69, v46, v41
    v_dot2_f32_bf16 v43, v69, v69, v43
    v_dot2_f32_bf16 v40, v70, v46, v40
    v_dot2_f32_bf16 v42, v70, v70, v42
    v_dot2_f32_bf16 v41, v71, v46, v41
    v_dot2_f32_bf16 v43, v71, v71, v43
    s_waitcnt lgkmcnt(1)
    v_dot2_f32_bf16 v40, v72, v46, v40
    v_dot2_f32_bf16 v42, v72, v72, v42
    v_dot2_f32_bf16 v41, v73, v46, v41
    v_dot2_f32_bf16 v43, v73, v73, v43
    v_dot2_f32_bf16 v40, v74, v46, v40
    v_dot2_f32_bf16 v42, v74, v74, v42
    v_dot2_f32_bf16 v41, v75, v46, v41
    v_dot2_f32_bf16 v43, v75, v75, v43
    s_waitcnt lgkmcnt(0)
    v_dot2_f32_bf16 v40, v76, v46, v40
    v_dot2_f32_bf16 v42, v76, v76, v42
    v_dot2_f32_bf16 v41, v77, v46, v41
    v_dot2_f32_bf16 v43, v77, v77, v43
    v_dot2_f32_bf16 v40, v78, v46, v40
    v_dot2_f32_bf16 v42, v78, v78, v42
    v_dot2_f32_bf16 v41, v79, v46, v41
    v_dot2_f32_bf16 v43, v79, v79, v43
    s_add_u32 s55, s55, 32768
    s_cmp_ge_u32 s55, 131072
    s_cselect_b32 s55, 0, s55
    s_waitcnt vmcnt(16)
    s_branch k1d_lbar
k1d_lnd:
    v_add_u32 v112, s55, v32
    ds_read_b128 v[64:67], v112
    v_add_u32 v113, s55, v33
    ds_read_b128 v[68:71], v113
    v_add_u32 v114, s55, v34
    ds_read_b128 v[72:75], v114
    v_add_u32 v115, s55, v35
    ds_read_b128 v[76:79], v115
    s_waitcnt lgkmcnt(3)
    v_dot2_f32_bf16 v40, v64, v46, v40
    v_dot2_f32_bf16 v42, v64, v64, v42
    v_dot2_f32_bf16 v41, v65, v46, v41
    v_dot2_f32_bf16 v43, v65, v65, v43
    v_dot2_f32_bf16 v40, v66, v46, v40
    v_dot2_f32_bf16 v42, v66, v66, v42
    v_dot2_f32_bf16 v41, v67, v46, v41
    v_dot2_f32_bf16 v43, v67, v67, v43
    s_waitcnt lgkmcnt(2)
    v_dot2_f32_bf16 v40, v68, v46, v40
    v_dot2_f32_bf16 v42, v68, v68, v42
    v_dot2_f32_bf16 v41, v69, v46, v41
    v_dot2_f32_bf16 v43, v69, v69, v43
    v_dot2_f32_bf16 v40, v70, v46, v40
    v_dot2_f32_bf16 v42, v70, v70, v42
    v_dot2_f32_bf16 v41, v71, v46, v41
    v_dot2_f32_bf16 v43, v71, v71, v43
    s_waitcnt lgkmcnt(1)
    v_dot2_f32_bf16 v40, v72, v46, v40
    v_dot2_f32_bf16 v42, v72, v72, v42
    v_dot2_f32_bf16 v41, v73, v46, v41
    v_dot2_f32_bf16 v43, v73, v73, v43
    v_dot2_f32_bf16 v40, v74, v46, v40
    v_dot2_f32_bf16 v42, v74, v74, v42
    v_dot2_f32_bf16 v41, v75, v46, v41
    v_dot2_f32_bf16 v43, v75, v75, v43
    s_waitcnt lgkmcnt(0)
    v_dot2_f32_bf16 v40, v76, v46, v40
    v_dot2_f32_bf16 v42, v76, v76, v42
    v_dot2_f32_bf16 v41, v77, v46, v41
    v_dot2_f32_bf16 v43, v77, v77, v43
    v_dot2_f32_bf16 v40, v78, v46, v40
    v_dot2_f32_bf16 v42, v78, v78, v42
    v_dot2_f32_bf16 v41, v79, v46, v41
    v_dot2_f32_bf16 v43, v79, v79, v43
    s_add_u32 s55, s55, 32768
    s_cmp_ge_u32 s55, 131072
    s_cselect_b32 s55, 0, s55
    s_waitcnt vmcnt(0)
k1d_lbar:
    s_barrier
    s_add_u32 s17, s17, 1
    s_cmp_lt_u32 s17, s50
    s_cbranch_scc1 k1d_lloop
    s_nop 3
    v_add_f32 v40, v40, v41
    v_add_f32 v42, v42, v43
    s_nop 1
    v_add_f32_dpp v40, v40, v40 quad_perm:[1,0,3,2] row_mask:0xf bank_mask:0xf
    v_add_f32_dpp v42, v42, v42 quad_perm:[1,0,3,2] row_mask:0xf bank_mask:0xf
    v_mul_f32 v40, 0x3b000000, v40
    v_mul_f32 v42, 0x3b000000, v42
    v_fma_f32 v42, -v40, v40, v42
    v_max_f32 v42, 0, v42
    v_cvt_pk_bf16_f32 v40, v40, v40
    v_lshlrev_b32 v40, 16, v40
    v_cvt_pk_bf16_f32 v42, v42, v42
    v_lshlrev_b32 v42, 16, v42
    v_add_f32 v42, 0x3727c5ac, v42
    v_cvt_pk_bf16_f32 v42, v42, v42
    v_lshlrev_b32 v42, 16, v42
    v_sqrt_f32 v42, v42
    s_nop 0
    v_cvt_pk_bf16_f32 v42, v42, v42
    v_lshlrev_b32 v42, 16, v42
    v_rcp_f32 v42, v42
    v_lshrrev_b32 v2, 1, v1
    s_lshl_b32 s24, s16, 5
    v_add_u32 v2, s24, v2
    v_lshlrev_b32 v2, 2, v2
    v_add_u32 v2, 131072, v2
    ds_write_b32 v2, v40
    ds_write_b32 v2, v42 offset:512
    s_waitcnt lgkmcnt(0)
    s_barrier
    s_branch k1d_ldone
k1d_cdone:
    s_cmp_lt_u32 s45, 4
    s_mov_b32 s26, 1.0
    s_cselect_b32 s26, s26, -1.0
    s_lshr_b32 s27, s16, 1
    s_and_b32 s28, s16, 1
    s_mul_i32 s29, s28, 17408
    s_mul_i32 s30, s27, 128
    s_add_u32 s29, s29, s30
    v_and_b32 v2, 15, v1
    v_lshrrev_b32 v3, 4, v1
    s_mul_i32 s30, s27, 256
    s_add_u32 s30, s30, 131072
    v_lshlrev_b32 v148, 4, v3
    v_add_u32 v148, s30, v148
    ds_read_b128 v[20:23], v148 offset:0
    ds_read_b128 v[36:39], v148 offset:512
    ds_read_b128 v[24:27], v148 offset:64
    ds_read_b128 v[40:43], v148 offset:576
    ds_read_b128 v[28:31], v148 offset:128
    ds_read_b128 v[44:47], v148 offset:640
    ds_read_b128 v[32:35], v148 offset:192
    ds_read_b128 v[48:51], v148 offset:704
    v_mul_u32_u24 v2, 272, v2
    v_lshl_add_u32 v2, v3, 3, v2
    v_add_u32 v2, s29, v2
    s_waitcnt lgkmcnt(0)
    v_mul_f32 v36, s26, v36
    v_mul_f32 v37, s26, v37
    v_mul_f32 v38, s26, v38
    v_mul_f32 v39, s26, v39
    v_mul_f32 v40, s26, v40
    v_mul_f32 v41, s26, v41
    v_mul_f32 v42, s26, v42
    v_mul_f32 v43, s26, v43
    v_mul_f32 v44, s26, v44
    v_mul_f32 v45, s26, v45
    v_mul_f32 v46, s26, v46
    v_mul_f32 v47, s26, v47
    v_mul_f32 v48, s26, v48
    v_mul_f32 v49, s26, v49
    v_mul_f32 v50, s26, v50
    v_mul_f32 v51, s26, v51
    v_fma_f32 v148, -v20, v156, v84
    v_mul_f32 v148, v148, v36
    v_fma_f32 v149, -v21, v156, v85
    v_mul_f32 v149, v149, v37
    v_fma_f32 v150, -v22, v156, v86
    v_mul_f32 v150, v150, v38
    v_fma_f32 v151, -v23, v156, v87
    v_mul_f32 v151, v151, v39
    v_cvt_pk_bf16_f32 v152, v148, v149
    v_cvt_pk_bf16_f32 v153, v150, v151
    ds_write_b64 v2, v[152:153] offset:0
    v_fma_f32 v148, -v24, v156, v100
    v_mul_f32 v148, v148, v40
    v_fma_f32 v149, -v25, v156, v101
    v_mul_f32 v149, v149, v41
    v_fma_f32 v150, -v26, v156, v102
    v_mul_f32 v150, v150, v42
    v_fma_f32 v151, -v27, v156, v103
    v_mul_f32 v151, v151, v43
    v_cvt_pk_bf16_f32 v154, v148, v149
    v_cvt_pk_bf16_f32 v155, v150, v151
    ds_write_b64 v2, v[154:155] offset:32
    v_fma_f32 v148, -v28, v156, v116
    v_mul_f32 v148, v148, v44
    v_fma_f32 v149, -v29, v156, v117
    v_mul_f32 v149, v149, v45
    v_fma_f32 v150, -v30, v156, v118
    v_mul_f32 v150, v150, v46
    v_fma_f32 v151, -v31, v156, v119
    v_mul_f32 v151, v151, v47
    v_cvt_pk_bf16_f32 v152, v148, v149
    v_cvt_pk_bf16_f32 v153, v150, v151
    ds_write_b64 v2, v[152:153] offset:64
    v_fma_f32 v148, -v32, v156, v132
    v_mul_f32 v148, v148, v48
    v_fma_f32 v149, -v33, v156, v133
    v_mul_f32 v149, v149, v49
    v_fma_f32 v150, -v34, v156, v134
    v_mul_f32 v150, v150, v50
    v_fma_f32 v151, -v35, v156, v135
    v_mul_f32 v151, v151, v51
    v_cvt_pk_bf16_f32 v154, v148, v149
    v_cvt_pk_bf16_f32 v155, v150, v151
    ds_write_b64 v2, v[154:155] offset:96
    v_fma_f32 v148, -v20, v160, v88
    v_mul_f32 v148, v148, v36
    v_fma_f32 v149, -v21, v160, v89
    v_mul_f32 v149, v149, v37
    v_fma_f32 v150, -v22, v160, v90
    v_mul_f32 v150, v150, v38
    v_fma_f32 v151, -v23, v160, v91
    v_mul_f32 v151, v151, v39
    v_cvt_pk_bf16_f32 v152, v148, v149
    v_cvt_pk_bf16_f32 v153, v150, v151
    ds_write_b64 v2, v[152:153] offset:4352
    v_fma_f32 v148, -v24, v160, v104
    v_mul_f32 v148, v148, v40
    v_fma_f32 v149, -v25, v160, v105
    v_mul_f32 v149, v149, v41
    v_fma_f32 v150, -v26, v160, v106
    v_mul_f32 v150, v150, v42
    v_fma_f32 v151, -v27, v160, v107
    v_mul_f32 v151, v151, v43
    v_cvt_pk_bf16_f32 v154, v148, v149
    v_cvt_pk_bf16_f32 v155, v150, v151
    ds_write_b64 v2, v[154:155] offset:4384
    v_fma_f32 v148, -v28, v160, v120
    v_mul_f32 v148, v148, v44
    v_fma_f32 v149, -v29, v160, v121
    v_mul_f32 v149, v149, v45
    v_fma_f32 v150, -v30, v160, v122
    v_mul_f32 v150, v150, v46
    v_fma_f32 v151, -v31, v160, v123
    v_mul_f32 v151, v151, v47
    v_cvt_pk_bf16_f32 v152, v148, v149
    v_cvt_pk_bf16_f32 v153, v150, v151
    ds_write_b64 v2, v[152:153] offset:4416
    v_fma_f32 v148, -v32, v160, v136
    v_mul_f32 v148, v148, v48
    v_fma_f32 v149, -v33, v160, v137
    v_mul_f32 v149, v149, v49
    v_fma_f32 v150, -v34, v160, v138
    v_mul_f32 v150, v150, v50
    v_fma_f32 v151, -v35, v160, v139
    v_mul_f32 v151, v151, v51
    v_cvt_pk_bf16_f32 v154, v148, v149
    v_cvt_pk_bf16_f32 v155, v150, v151
    ds_write_b64 v2, v[154:155] offset:4448
    v_fma_f32 v148, -v20, v164, v92
    v_mul_f32 v148, v148, v36
    v_fma_f32 v149, -v21, v164, v93
    v_mul_f32 v149, v149, v37
    v_fma_f32 v150, -v22, v164, v94
    v_mul_f32 v150, v150, v38
    v_fma_f32 v151, -v23, v164, v95
    v_mul_f32 v151, v151, v39
    v_cvt_pk_bf16_f32 v152, v148, v149
    v_cvt_pk_bf16_f32 v153, v150, v151
    ds_write_b64 v2, v[152:153] offset:8704
    v_fma_f32 v148, -v24, v164, v108
    v_mul_f32 v148, v148, v40
    v_fma_f32 v149, -v25, v164, v109
    v_mul_f32 v149, v149, v41
    v_fma_f32 v150, -v26, v164, v110
    v_mul_f32 v150, v150, v42
    v_fma_f32 v151, -v27, v164, v111
    v_mul_f32 v151, v151, v43
    v_cvt_pk_bf16_f32 v154, v148, v149
    v_cvt_pk_bf16_f32 v155, v150, v151
    ds_write_b64 v2, v[154:155] offset:8736
    v_fma_f32 v148, -v28, v164, v124
    v_mul_f32 v148, v148, v44
    v_fma_f32 v149, -v29, v164, v125
    v_mul_f32 v149, v149, v45
    v_fma_f32 v150, -v30, v164, v126
    v_mul_f32 v150, v150, v46
    v_fma_f32 v151, -v31, v164, v127
    v_mul_f32 v151, v151, v47
    v_cvt_pk_bf16_f32 v152, v148, v149
    v_cvt_pk_bf16_f32 v153, v150, v151
    ds_write_b64 v2, v[152:153] offset:8768
    v_fma_f32 v148, -v32, v164, v140
    v_mul_f32 v148, v148, v48
    v_fma_f32 v149, -v33, v164, v141
    v_mul_f32 v149, v149, v49
    v_fma_f32 v150, -v34, v164, v142
    v_mul_f32 v150, v150, v50
    v_fma_f32 v151, -v35, v164, v143
    v_mul_f32 v151, v151, v51
    v_cvt_pk_bf16_f32 v154, v148, v149
    v_cvt_pk_bf16_f32 v155, v150, v151
    ds_write_b64 v2, v[154:155] offset:8800
    v_fma_f32 v148, -v20, v168, v96
    v_mul_f32 v148, v148, v36
    v_fma_f32 v149, -v21, v168, v97
    v_mul_f32 v149, v149, v37
    v_fma_f32 v150, -v22, v168, v98
    v_mul_f32 v150, v150, v38
    v_fma_f32 v151, -v23, v168, v99
    v_mul_f32 v151, v151, v39
    v_cvt_pk_bf16_f32 v152, v148, v149
    v_cvt_pk_bf16_f32 v153, v150, v151
    ds_write_b64 v2, v[152:153] offset:13056
    v_fma_f32 v148, -v24, v168, v112
    v_mul_f32 v148, v148, v40
    v_fma_f32 v149, -v25, v168, v113
    v_mul_f32 v149, v149, v41
    v_fma_f32 v150, -v26, v168, v114
    v_mul_f32 v150, v150, v42
    v_fma_f32 v151, -v27, v168, v115
    v_mul_f32 v151, v151, v43
    v_cvt_pk_bf16_f32 v154, v148, v149
    v_cvt_pk_bf16_f32 v155, v150, v151
    ds_write_b64 v2, v[154:155] offset:13088
    v_fma_f32 v148, -v28, v168, v128
    v_mul_f32 v148, v148, v44
    v_fma_f32 v149, -v29, v168, v129
    v_mul_f32 v149, v149, v45
    v_fma_f32 v150, -v30, v168, v130
    v_mul_f32 v150, v150, v46
    v_fma_f32 v151, -v31, v168, v131
    v_mul_f32 v151, v151, v47
    v_cvt_pk_bf16_f32 v152, v148, v149
    v_cvt_pk_bf16_f32 v153, v150, v151
    ds_write_b64 v2, v[152:153] offset:13120
    v_fma_f32 v148, -v32, v168, v144
    v_mul_f32 v148, v148, v48
    v_fma_f32 v149, -v33, v168, v145
    v_mul_f32 v149, v149, v49
    v_fma_f32 v150, -v34, v168, v146
    v_mul_f32 v150, v150, v50
    v_fma_f32 v151, -v35, v168, v147
    v_mul_f32 v151, v151, v51
    v_cvt_pk_bf16_f32 v154, v148, v149
    v_cvt_pk_bf16_f32 v155, v150, v151
    ds_write_b64 v2, v[154:155] offset:13152
    s_waitcnt lgkmcnt(0)
k1d_ldone:
    s_barrier
    s_add_u32 s12, s32, 2097152
    s_addc_u32 s13, s33, 0
    s_and_b32 s13, s13, 0xffff
    s_mov_b32 s14, 6029312
    s_mov_b32 s15, 0x00020000
    s_cmp_lt_u32 s45, 4
    s_cselect_b32 s24, 0, 4096
    s_mul_i32 s25, s47, 11776
    s_add_u32 s25, s25, s24
    s_lshl_b32 s24, s46, 1
    s_add_u32 s31, s25, s24
    v_add_u32 v4, 0, v0
    v_lshrrev_b32 v5, 4, v4
    v_and_b32 v6, 15, v4
    v_lshlrev_b32 v6, 4, v6
    v_mul_u32_u24 v7, 272, v5
    v_add_u32 v7, v7, v6
    ds_read_b128 v[8:11], v7
    s_mov_b32 s24, 11776
    v_mul_lo_u32 v5, v5, s24
    v_add_u32 v48, v5, v6
    v_add_u32 v4, 512, v0
    v_lshrrev_b32 v5, 4, v4
    v_and_b32 v6, 15, v4
    v_lshlrev_b32 v6, 4, v6
    v_mul_u32_u24 v7, 272, v5
    v_add_u32 v7, v7, v6
    ds_read_b128 v[12:15], v7
    s_mov_b32 s24, 11776
    v_mul_lo_u32 v5, v5, s24
    v_add_u32 v49, v5, v6
    v_add_u32 v4, 1024, v0
    v_lshrrev_b32 v5, 4, v4
    v_and_b32 v6, 15, v4
    v_lshlrev_b32 v6, 4, v6
    v_mul_u32_u24 v7, 272, v5
    v_add_u32 v7, v7, v6
    ds_read_b128 v[16:19], v7
    s_mov_b32 s24, 11776
    v_mul_lo_u32 v5, v5, s24
    v_add_u32 v50, v5, v6
    v_add_u32 v4, 1536, v0
    v_lshrrev_b32 v5, 4, v4
    v_and_b32 v6, 15, v4
    v_lshlrev_b32 v6, 4, v6
    v_mul_u32_u24 v7, 272, v5
    v_add_u32 v7, v7, v6
    ds_read_b128 v[20:23], v7
    s_mov_b32 s24, 11776
    v_mul_lo_u32 v5, v5, s24
    v_add_u32 v51, v5, v6
    s_waitcnt lgkmcnt(3)
    buffer_store_dwordx4 v[8:11], v48, s[12:15], s31 offen
    s_waitcnt lgkmcnt(2)
    buffer_store_dwordx4 v[12:15], v49, s[12:15], s31 offen
    s_waitcnt lgkmcnt(1)
    buffer_store_dwordx4 v[16:19], v50, s[12:15], s31 offen
    s_waitcnt lgkmcnt(0)
    buffer_store_dwordx4 v[20:23], v51, s[12:15], s31 offen
    s_cmp_lg_u32 s53, 0
    s_cbranch_scc1 L_k1_end
    s_lshl_b32 s24, s44, 3
    s_add_u32 s24, s24, s45
    s_cmp_ge_u32 s24, 112
    s_cbranch_scc1 L_k1_end
    s_lshr_b32 s25, s24, 2
    s_and_b32 s26, s24, 3
    s_mov_b32 s8, s42
    s_and_b32 s9, s43, 0xffff
    s_mov_b32 s10, 1835008
    s_mov_b32 s11, 0x00020000
    s_lshl_b32 s27, s16, 8
    s_mul_i32 s28, s25, 65536
    s_lshl_b32 s29, s26, 8
    s_add_u32 s28, s28, s29
    v_add_u32 v148, s27, v1
    v_lshrrev_b32 v149, 4, v148
    v_and_b32 v150, 15, v148
    v_and_b32 v151, 3, v149
    v_lshrrev_b32 v152, 1, v149
    v_and_b32 v152, 4, v152
    v_or_b32 v151, v151, v152
    v_lshlrev_b32 v151, 1, v151
    v_xor_b32 v150, v150, v151
    v_lshlrev_b32 v150, 4, v150
    v_lshl_add_u32 v156, v149, 10, v150
    v_add_u32 v148, s27, v1
    v_add_u32 v148, 64, v148
    v_lshrrev_b32 v149, 4, v148
    v_and_b32 v150, 15, v148
    v_and_b32 v151, 3, v149
    v_lshrrev_b32 v152, 1, v149
    v_and_b32 v152, 4, v152
    v_or_b32 v151, v151, v152
    v_lshlrev_b32 v151, 1, v151
    v_xor_b32 v150, v150, v151
    v_lshlrev_b32 v150, 4, v150
    v_lshl_add_u32 v157, v149, 10, v150
    v_subrev_u32 v157, 1024, v157
    v_add_u32 v148, s27, v1
    v_add_u32 v148, 128, v148
    v_lshrrev_b32 v149, 4, v148
    v_and_b32 v150, 15, v148
    v_and_b32 v151, 3, v149
    v_lshrrev_b32 v152, 1, v149
    v_and_b32 v152, 4, v152
    v_or_b32 v151, v151, v152
    v_lshlrev_b32 v151, 1, v151
    v_xor_b32 v150, v150, v151
    v_lshlrev_b32 v150, 4, v150
    v_lshl_add_u32 v158, v149, 10, v150
    v_subrev_u32 v158, 2048, v158
    v_add_u32 v148, s27, v1
    v_add_u32 v148, 192, v148
    v_lshrrev_b32 v149, 4, v148
    v_and_b32 v150, 15, v148
    v_and_b32 v151, 3, v149
    v_lshrrev_b32 v152, 1, v149
    v_and_b32 v152, 4, v152
    v_or_b32 v151, v151, v152
    v_lshlrev_b32 v151, 1, v151
    v_xor_b32 v150, v150, v151
    v_lshlrev_b32 v150, 4, v150
    v_lshl_add_u32 v159, v149, 10, v150
    v_subrev_u32 v159, 3072, v159
    s_lshl_b32 s29, s16, 12
    s_add_u32 m0, s29, 65536
    s_nop 0
    buffer_load_dwordx4 v156, s[8:11], s28 offen lds
    buffer_load_dwordx4 v157, s[8:11], s28 offen offset:1024 lds
    buffer_load_dwordx4 v158, s[8:11], s28 offen offset:2048 lds
    buffer_load_dwordx4 v159, s[8:11], s28 offen offset:3072 lds
    s_waitcnt vmcnt(0)
    s_barrier
    v_and_b32 v2, 15, v1
    v_lshrrev_b32 v3, 4, v1
    v_lshrrev_b32 v148, 2, v2
    v_lshl_add_u32 v149, v3, 3, v148
    v_lshlrev_b32 v149, 8, v149
    v_and_b32 v150, 1, v3
    v_lshl_or_b32 v150, v150, 2, v148
    v_lshl_add_u32 v149, v150, 5, v149
    v_and_b32 v150, 3, v2
    v_lshl_add_u32 v149, v150, 3, v149
    s_lshl_b32 s29, s16, 6
    v_xor_b32 v150, s29, v149
    v_xor_b32 v151, 32, v150
    v_add_u32 v150, 65536, v150
    v_add_u32 v151, 65536, v151
    ds_read_b64_tr_b16 v[20:21], v150 offset:0
    ds_read_b64_tr_b16 v[22:23], v150 offset:1024
    ds_read_b64_tr_b16 v[24:25], v150 offset:8192
    ds_read_b64_tr_b16 v[26:27], v150 offset:9216
    ds_read_b64_tr_b16 v[28:29], v151 offset:0
    ds_read_b64_tr_b16 v[30:31], v151 offset:1024
    ds_read_b64_tr_b16 v[32:33], v151 offset:8192
    ds_read_b64_tr_b16 v[34:35], v151 offset:9216
    s_lshl_b32 s29, s26, 7
    s_lshl_b32 s30, s16, 5
    s_add_u32 s29, s29, s30
    v_add_u32 v148, s29, v2
    s_mov_b32 s31, 11776
    v_mul_lo_u32 v148, v148, s31
    v_lshl_add_u32 v148, v3, 4, v148
    s_lshl_b32 s30, s25, 7
    s_add_u32 s30, s30, 8192
    v_add_u32 v148, s30, v148
    v_add_u32 v149, 188416, v148
    s_waitcnt lgkmcnt(0)
    buffer_store_dwordx4 v[20:23], v148, s[12:15], 0 offen offset:0
    buffer_store_dwordx4 v[24:27], v148, s[12:15], 0 offen offset:64
    buffer_store_dwordx4 v[28:31], v149, s[12:15], 0 offen offset:0
    buffer_store_dwordx4 v[32:35], v149, s[12:15], 0 offen offset:64
    s_branch L_k1_end
L_k1_mlp:
    s_mov_b32 s8, s38
    s_and_b32 s9, s39, 0xffff
    s_mov_b32 s10, 1835008
    s_mov_b32 s11, 0x00020000
    s_sub_u32 s47, s45, 8
    s_mul_i32 s47, s47, 224
    s_mov_b32 s54, s18
    s_cmp_lg_u32 s53, 0
    s_cbranch_scc1 k1m_loader
    s_lshr_b32 s24, s16, 1
    s_and_b32 s25, s16, 1
    v_and_b32 v2, 15, v1
    v_lshrrev_b32 v3, 4, v1
    v_and_b32 v216, 7, v1
    v_xor_b32 v216, v216, v3
    v_lshlrev_b32 v216, 4, v216
    s_mul_i32 s12, s24, 8192
    v_lshl_add_u32 v217, v2, 7, v216
    v_add_u32 v217, s12, v217
    v_add_u32 v4, 0, v217
    v_xor_b32 v5, 64, v4
    v_add_u32 v8, 45056, v217
    v_xor_b32 v9, 64, v8
    v_add_u32 v12, 90112, v217
    v_xor_b32 v13, 64, v12
    v_lshrrev_b32 v216, 2, v2
    v_lshl_add_u32 v216, v3, 3, v216
    v_mul_u32_u24 v216, 448, v216
    v_and_b32 v217, 3, v2
    v_lshl_add_u32 v216, v217, 3, v216
    s_mul_i32 s12, s25, 224
    s_add_u32 s12, s12, 16384
    v_add_u32 v216, s12, v216
    v_and_b32 v217, 1, v3
    v_lshlrev_b32 v217, 5, v217
    s_mul_i32 s12, s25, 7
    s_and_b32 s12, s12, 1
    s_lshl_b32 s12, s12, 1
    s_sub_u32 s12, 1, s12
    v_mul_lo_u32 v217, v217, s12
    v_add_u32 v218, v216, v217
    v_sub_u32 v219, v216, v217
    v_add_u32 v6, 0, v218
    v_add_u32 v7, 0, v219
    v_add_u32 v10, 45056, v218
    v_add_u32 v11, 45056, v219
    v_add_u32 v14, 90112, v218
    v_add_u32 v15, 90112, v219
    v_mov_b32 v104, 0
    v_mov_b32 v105, 0
    v_mov_b32 v106, 0
    v_mov_b32 v107, 0
    v_mov_b32 v108, 0
    v_mov_b32 v109, 0
    v_mov_b32 v110, 0
    v_mov_b32 v111, 0
    v_mov_b32 v112, 0
    v_mov_b32 v113, 0
    v_mov_b32 v114, 0
    v_mov_b32 v115, 0
    v_mov_b32 v116, 0
    v_mov_b32 v117, 0
    v_mov_b32 v118, 0
    v_mov_b32 v119, 0
    v_mov_b32 v120, 0
    v_mov_b32 v121, 0
    v_mov_b32 v122, 0
    v_mov_b32 v123, 0
    v_mov_b32 v124, 0
    v_mov_b32 v125, 0
    v_mov_b32 v126, 0
    v_mov_b32 v127, 0
    v_mov_b32 v128, 0
    v_mov_b32 v129, 0
    v_mov_b32 v130, 0
    v_mov_b32 v131, 0
    v_mov_b32 v132, 0
    v_mov_b32 v133, 0
    v_mov_b32 v134, 0
    v_mov_b32 v135, 0
    v_mov_b32 v136, 0
    v_mov_b32 v137, 0
    v_mov_b32 v138, 0
    v_mov_b32 v139, 0
    v_mov_b32 v140, 0
    v_mov_b32 v141, 0
    v_mov_b32 v142, 0
    v_mov_b32 v143, 0
    v_mov_b32 v144, 0
    v_mov_b32 v145, 0
    v_mov_b32 v146, 0
    v_mov_b32 v147, 0
    v_mov_b32 v148, 0
    v_mov_b32 v149, 0
    v_mov_b32 v150, 0
    v_mov_b32 v151, 0
    v_mov_b32 v152, 0
    v_mov_b32 v153, 0
    v_mov_b32 v154, 0
    v_mov_b32 v155, 0
    v_mov_b32 v156, 0
    v_mov_b32 v157, 0
    v_mov_b32 v158, 0
    v_mov_b32 v159, 0
    v_mov_b32 v160, 0
    v_mov_b32 v161, 0
    v_mov_b32 v162, 0
    v_mov_b32 v163, 0
    v_mov_b32 v164, 0
    v_mov_b32 v165, 0
    v_mov_b32 v166, 0
    v_mov_b32 v167, 0
    v_mov_b32 v168, 0
    v_mov_b32 v169, 0
    v_mov_b32 v170, 0
    v_mov_b32 v171, 0
    v_mov_b32 v172, 0
    v_mov_b32 v173, 0
    v_mov_b32 v174, 0
    v_mov_b32 v175, 0
    v_mov_b32 v176, 0
    v_mov_b32 v177, 0
    v_mov_b32 v178, 0
    v_mov_b32 v179, 0
    v_mov_b32 v180, 0
    v_mov_b32 v181, 0
    v_mov_b32 v182, 0
    v_mov_b32 v183, 0
    v_mov_b32 v184, 0
    v_mov_b32 v185, 0
    v_mov_b32 v186, 0
    v_mov_b32 v187, 0
    v_mov_b32 v188, 0
    v_mov_b32 v189, 0
    v_mov_b32 v190, 0
    v_mov_b32 v191, 0
    v_mov_b32 v192, 0
    v_mov_b32 v193, 0
    v_mov_b32 v194, 0
    v_mov_b32 v195, 0
    v_mov_b32 v196, 0
    v_mov_b32 v197, 0
    v_mov_b32 v198, 0
    v_mov_b32 v199, 0
    v_mov_b32 v200, 0
    v_mov_b32 v201, 0
    v_mov_b32 v202, 0
    v_mov_b32 v203, 0
    v_mov_b32 v204, 0
    v_mov_b32 v205, 0
    v_mov_b32 v206, 0
    v_mov_b32 v207, 0
    v_mov_b32 v208, 0
    v_mov_b32 v209, 0
    v_mov_b32 v210, 0
    v_mov_b32 v211, 0
    v_mov_b32 v212, 0
    v_mov_b32 v213, 0
    v_mov_b32 v214, 0
    v_mov_b32 v215, 0
    v_mov_b32 v224, 0
    v_mov_b32 v225, 0
    v_mov_b32 v226, 0
    v_mov_b32 v227, 0
    v_mov_b32 v228, 0
    v_mov_b32 v229, 0
    v_mov_b32 v230, 0
    v_mov_b32 v231, 0
    v_mov_b32 v232, 0
    v_mov_b32 v233, 0
    v_mov_b32 v234, 0
    v_mov_b32 v235, 0
    v_mov_b32 v236, 0
    v_mov_b32 v237, 0
    v_mov_b32 v238, 0
    v_mov_b32 v239, 0
    v_mov_b32 v240, 0
    v_mov_b32 v241, 0
    v_mov_b32 v242, 0
    v_mov_b32 v243, 0
    v_mov_b32 v244, 0
    v_mov_b32 v245, 0
    v_mov_b32 v246, 0
    v_mov_b32 v247, 0
    v_mov_b32 v248, 0
    v_mov_b32 v249, 0
    v_mov_b32 v250, 0
    v_mov_b32 v251, 0
    v_mov_b32 v252, 0x3f803f80
    v_mov_b32 v253, 0x3f803f80
    v_mov_b32 v254, 0x3f803f80
    v_mov_b32 v255, 0x3f803f80
    s_barrier
    ds_read_b128 v[16:19], v4 offset:0
    ds_read_b128 v[20:23], v4 offset:2048
    ds_read_b128 v[24:27], v4 offset:4096
    ds_read_b128 v[28:31], v4 offset:6144
    ds_read_b64_tr_b16 v[48:49], v6 offset:0
    ds_read_b64_tr_b16 v[50:51], v6 offset:1792
    ds_read_b64_tr_b16 v[52:53], v7 offset:32
    ds_read_b64_tr_b16 v[54:55], v7 offset:1824
    ds_read_b64_tr_b16 v[56:57], v6 offset:64
    ds_read_b64_tr_b16 v[58:59], v6 offset:1856
    ds_read_b64_tr_b16 v[60:61], v7 offset:96
    ds_read_b64_tr_b16 v[62:63], v7 offset:1888
    ds_read_b64_tr_b16 v[64:65], v6 offset:128
    ds_read_b64_tr_b16 v[66:67], v6 offset:1920
    ds_read_b64_tr_b16 v[68:69], v7 offset:160
    ds_read_b64_tr_b16 v[70:71], v7 offset:1952
    ds_read_b64_tr_b16 v[72:73], v6 offset:192
    ds_read_b64_tr_b16 v[74:75], v6 offset:1984
    s_waitcnt lgkmcnt(0)
    v_mfma_f32_16x16x32_bf16 v[104:107], v[48:51], v[16:19], v[104:107]
    ds_read_b128 v[32:35], v5 offset:0
    v_mfma_f32_16x16x32_bf16 v[108:111], v[52:55], v[16:19], v[108:111]
    ds_read_b128 v[36:39], v5 offset:2048
    v_mfma_f32_16x16x32_bf16 v[112:115], v[56:59], v[16:19], v[112:115]
    v_mfma_f32_16x16x32_bf16 v[116:119], v[60:63], v[16:19], v[116:119]
    ds_read_b128 v[40:43], v5 offset:4096
    v_mfma_f32_16x16x32_bf16 v[120:123], v[64:67], v[16:19], v[120:123]
    v_mfma_f32_16x16x32_bf16 v[124:127], v[68:71], v[16:19], v[124:127]
    ds_read_b128 v[44:47], v5 offset:6144
    v_mfma_f32_16x16x32_bf16 v[128:131], v[72:75], v[16:19], v[128:131]
    v_mfma_f32_16x16x32_bf16 v[132:135], v[48:51], v[20:23], v[132:135]
    ds_read_b64_tr_b16 v[76:77], v6 offset:14336
    v_mfma_f32_16x16x32_bf16 v[136:139], v[52:55], v[20:23], v[136:139]
    ds_read_b64_tr_b16 v[78:79], v6 offset:16128
    v_mfma_f32_16x16x32_bf16 v[140:143], v[56:59], v[20:23], v[140:143]
    v_mfma_f32_16x16x32_bf16 v[144:147], v[60:63], v[20:23], v[144:147]
    ds_read_b64_tr_b16 v[80:81], v7 offset:14368
    v_mfma_f32_16x16x32_bf16 v[148:151], v[64:67], v[20:23], v[148:151]
    v_mfma_f32_16x16x32_bf16 v[152:155], v[68:71], v[20:23], v[152:155]
    ds_read_b64_tr_b16 v[82:83], v7 offset:16160
    v_mfma_f32_16x16x32_bf16 v[156:159], v[72:75], v[20:23], v[156:159]
    v_mfma_f32_16x16x32_bf16 v[160:163], v[48:51], v[24:27], v[160:163]
    ds_read_b64_tr_b16 v[84:85], v6 offset:14400
    v_mfma_f32_16x16x32_bf16 v[164:167], v[52:55], v[24:27], v[164:167]
    v_mfma_f32_16x16x32_bf16 v[168:171], v[56:59], v[24:27], v[168:171]
    ds_read_b64_tr_b16 v[86:87], v6 offset:16192
    v_mfma_f32_16x16x32_bf16 v[172:175], v[60:63], v[24:27], v[172:175]
    ds_read_b64_tr_b16 v[88:89], v7 offset:14432
    v_mfma_f32_16x16x32_bf16 v[176:179], v[64:67], v[24:27], v[176:179]
    v_mfma_f32_16x16x32_bf16 v[180:183], v[68:71], v[24:27], v[180:183]
    ds_read_b64_tr_b16 v[90:91], v7 offset:16224
    v_mfma_f32_16x16x32_bf16 v[184:187], v[72:75], v[24:27], v[184:187]
    v_mfma_f32_16x16x32_bf16 v[188:191], v[48:51], v[28:31], v[188:191]
    ds_read_b64_tr_b16 v[92:93], v6 offset:14464
    v_mfma_f32_16x16x32_bf16 v[192:195], v[52:55], v[28:31], v[192:195]
    v_mfma_f32_16x16x32_bf16 v[196:199], v[56:59], v[28:31], v[196:199]
    ds_read_b64_tr_b16 v[94:95], v6 offset:16256
    v_mfma_f32_16x16x32_bf16 v[200:203], v[60:63], v[28:31], v[200:203]
    ds_read_b64_tr_b16 v[96:97], v7 offset:14496
    v_mfma_f32_16x16x32_bf16 v[204:207], v[64:67], v[28:31], v[204:207]
    v_mfma_f32_16x16x32_bf16 v[208:211], v[68:71], v[28:31], v[208:211]
    ds_read_b64_tr_b16 v[98:99], v7 offset:16288
    v_mfma_f32_16x16x32_bf16 v[212:215], v[72:75], v[28:31], v[212:215]
    v_mfma_f32_16x16x32_bf16 v[224:227], v[48:51], v[252:255], v[224:227]
    ds_read_b64_tr_b16 v[100:101], v6 offset:14528
    v_mfma_f32_16x16x32_bf16 v[228:231], v[52:55], v[252:255], v[228:231]
    v_mfma_f32_16x16x32_bf16 v[232:235], v[56:59], v[252:255], v[232:235]
    ds_read_b64_tr_b16 v[102:103], v6 offset:16320
    v_mfma_f32_16x16x32_bf16 v[236:239], v[60:63], v[252:255], v[236:239]
    v_mfma_f32_16x16x32_bf16 v[240:243], v[64:67], v[252:255], v[240:243]
    v_mfma_f32_16x16x32_bf16 v[244:247], v[68:71], v[252:255], v[244:247]
    v_mfma_f32_16x16x32_bf16 v[248:251], v[72:75], v[252:255], v[248:251]
    s_waitcnt lgkmcnt(0)
    s_barrier
    s_sub_u32 s18, s18, 1
k1m_cloop:
    v_mfma_f32_16x16x32_bf16 v[104:107], v[76:79], v[32:35], v[104:107]
    ds_read_b128 v[16:19], v8 offset:0
    v_mfma_f32_16x16x32_bf16 v[108:111], v[80:83], v[32:35], v[108:111]
    ds_read_b128 v[20:23], v8 offset:2048
    v_mfma_f32_16x16x32_bf16 v[112:115], v[84:87], v[32:35], v[112:115]
    v_mfma_f32_16x16x32_bf16 v[116:119], v[88:91], v[32:35], v[116:119]
    ds_read_b128 v[24:27], v8 offset:4096
    v_mfma_f32_16x16x32_bf16 v[120:123], v[92:95], v[32:35], v[120:123]
    v_mfma_f32_16x16x32_bf16 v[124:127], v[96:99], v[32:35], v[124:127]
    ds_read_b128 v[28:31], v8 offset:6144
    v_mfma_f32_16x16x32_bf16 v[128:131], v[100:103], v[32:35], v[128:131]
    v_mfma_f32_16x16x32_bf16 v[132:135], v[76:79], v[36:39], v[132:135]
    ds_read_b64_tr_b16 v[48:49], v10 offset:0
    v_mfma_f32_16x16x32_bf16 v[136:139], v[80:83], v[36:39], v[136:139]
    ds_read_b64_tr_b16 v[50:51], v10 offset:1792
    v_mfma_f32_16x16x32_bf16 v[140:143], v[84:87], v[36:39], v[140:143]
    v_mfma_f32_16x16x32_bf16 v[144:147], v[88:91], v[36:39], v[144:147]
    ds_read_b64_tr_b16 v[52:53], v11 offset:32
    v_mfma_f32_16x16x32_bf16 v[148:151], v[92:95], v[36:39], v[148:151]
    v_mfma_f32_16x16x32_bf16 v[152:155], v[96:99], v[36:39], v[152:155]
    ds_read_b64_tr_b16 v[54:55], v11 offset:1824
    v_mfma_f32_16x16x32_bf16 v[156:159], v[100:103], v[36:39], v[156:159]
    v_mfma_f32_16x16x32_bf16 v[160:163], v[76:79], v[40:43], v[160:163]
    ds_read_b64_tr_b16 v[56:57], v10 offset:64
    v_mfma_f32_16x16x32_bf16 v[164:167], v[80:83], v[40:43], v[164:167]
    v_mfma_f32_16x16x32_bf16 v[168:171], v[84:87], v[40:43], v[168:171]
    ds_read_b64_tr_b16 v[58:59], v10 offset:1856
    v_mfma_f32_16x16x32_bf16 v[172:175], v[88:91], v[40:43], v[172:175]
    ds_read_b64_tr_b16 v[60:61], v11 offset:96
    v_mfma_f32_16x16x32_bf16 v[176:179], v[92:95], v[40:43], v[176:179]
    v_mfma_f32_16x16x32_bf16 v[180:183], v[96:99], v[40:43], v[180:183]
    ds_read_b64_tr_b16 v[62:63], v11 offset:1888
    v_mfma_f32_16x16x32_bf16 v[184:187], v[100:103], v[40:43], v[184:187]
    v_mfma_f32_16x16x32_bf16 v[188:191], v[76:79], v[44:47], v[188:191]
    ds_read_b64_tr_b16 v[64:65], v10 offset:128
    v_mfma_f32_16x16x32_bf16 v[192:195], v[80:83], v[44:47], v[192:195]
    v_mfma_f32_16x16x32_bf16 v[196:199], v[84:87], v[44:47], v[196:199]
    ds_read_b64_tr_b16 v[66:67], v10 offset:1920
    v_mfma_f32_16x16x32_bf16 v[200:203], v[88:91], v[44:47], v[200:203]
    ds_read_b64_tr_b16 v[68:69], v11 offset:160
    v_mfma_f32_16x16x32_bf16 v[204:207], v[92:95], v[44:47], v[204:207]
    v_mfma_f32_16x16x32_bf16 v[208:211], v[96:99], v[44:47], v[208:211]
    ds_read_b64_tr_b16 v[70:71], v11 offset:1952
    v_mfma_f32_16x16x32_bf16 v[212:215], v[100:103], v[44:47], v[212:215]
    v_mfma_f32_16x16x32_bf16 v[224:227], v[76:79], v[252:255], v[224:227]
    ds_read_b64_tr_b16 v[72:73], v10 offset:192
    v_mfma_f32_16x16x32_bf16 v[228:231], v[80:83], v[252:255], v[228:231]
    v_mfma_f32_16x16x32_bf16 v[232:235], v[84:87], v[252:255], v[232:235]
    ds_read_b64_tr_b16 v[74:75], v10 offset:1984
    v_mfma_f32_16x16x32_bf16 v[236:239], v[88:91], v[252:255], v[236:239]
    v_mfma_f32_16x16x32_bf16 v[240:243], v[92:95], v[252:255], v[240:243]
    v_mfma_f32_16x16x32_bf16 v[244:247], v[96:99], v[252:255], v[244:247]
    v_mfma_f32_16x16x32_bf16 v[248:251], v[100:103], v[252:255], v[248:251]
    s_waitcnt lgkmcnt(0)
    v_mfma_f32_16x16x32_bf16 v[104:107], v[48:51], v[16:19], v[104:107]
    ds_read_b128 v[32:35], v9 offset:0
    v_mfma_f32_16x16x32_bf16 v[108:111], v[52:55], v[16:19], v[108:111]
    ds_read_b128 v[36:39], v9 offset:2048
    v_mfma_f32_16x16x32_bf16 v[112:115], v[56:59], v[16:19], v[112:115]
    v_mfma_f32_16x16x32_bf16 v[116:119], v[60:63], v[16:19], v[116:119]
    ds_read_b128 v[40:43], v9 offset:4096
    v_mfma_f32_16x16x32_bf16 v[120:123], v[64:67], v[16:19], v[120:123]
    v_mfma_f32_16x16x32_bf16 v[124:127], v[68:71], v[16:19], v[124:127]
    ds_read_b128 v[44:47], v9 offset:6144
    v_mfma_f32_16x16x32_bf16 v[128:131], v[72:75], v[16:19], v[128:131]
    v_mfma_f32_16x16x32_bf16 v[132:135], v[48:51], v[20:23], v[132:135]
    ds_read_b64_tr_b16 v[76:77], v10 offset:14336
    v_mfma_f32_16x16x32_bf16 v[136:139], v[52:55], v[20:23], v[136:139]
    ds_read_b64_tr_b16 v[78:79], v10 offset:16128
    v_mfma_f32_16x16x32_bf16 v[140:143], v[56:59], v[20:23], v[140:143]
    v_mfma_f32_16x16x32_bf16 v[144:147], v[60:63], v[20:23], v[144:147]
    ds_read_b64_tr_b16 v[80:81], v11 offset:14368
    v_mfma_f32_16x16x32_bf16 v[148:151], v[64:67], v[20:23], v[148:151]
    v_mfma_f32_16x16x32_bf16 v[152:155], v[68:71], v[20:23], v[152:155]
    ds_read_b64_tr_b16 v[82:83], v11 offset:16160
    v_mfma_f32_16x16x32_bf16 v[156:159], v[72:75], v[20:23], v[156:159]
    v_mfma_f32_16x16x32_bf16 v[160:163], v[48:51], v[24:27], v[160:163]
    ds_read_b64_tr_b16 v[84:85], v10 offset:14400
    v_mfma_f32_16x16x32_bf16 v[164:167], v[52:55], v[24:27], v[164:167]
    v_mfma_f32_16x16x32_bf16 v[168:171], v[56:59], v[24:27], v[168:171]
    ds_read_b64_tr_b16 v[86:87], v10 offset:16192
    v_mfma_f32_16x16x32_bf16 v[172:175], v[60:63], v[24:27], v[172:175]
    ds_read_b64_tr_b16 v[88:89], v11 offset:14432
    v_mfma_f32_16x16x32_bf16 v[176:179], v[64:67], v[24:27], v[176:179]
    v_mfma_f32_16x16x32_bf16 v[180:183], v[68:71], v[24:27], v[180:183]
    ds_read_b64_tr_b16 v[90:91], v11 offset:16224
    v_mfma_f32_16x16x32_bf16 v[184:187], v[72:75], v[24:27], v[184:187]
    v_mfma_f32_16x16x32_bf16 v[188:191], v[48:51], v[28:31], v[188:191]
    ds_read_b64_tr_b16 v[92:93], v10 offset:14464
    v_mfma_f32_16x16x32_bf16 v[192:195], v[52:55], v[28:31], v[192:195]
    v_mfma_f32_16x16x32_bf16 v[196:199], v[56:59], v[28:31], v[196:199]
    ds_read_b64_tr_b16 v[94:95], v10 offset:16256
    v_mfma_f32_16x16x32_bf16 v[200:203], v[60:63], v[28:31], v[200:203]
    ds_read_b64_tr_b16 v[96:97], v11 offset:14496
    v_mfma_f32_16x16x32_bf16 v[204:207], v[64:67], v[28:31], v[204:207]
    v_mfma_f32_16x16x32_bf16 v[208:211], v[68:71], v[28:31], v[208:211]
    ds_read_b64_tr_b16 v[98:99], v11 offset:16288
    v_mfma_f32_16x16x32_bf16 v[212:215], v[72:75], v[28:31], v[212:215]
    v_mfma_f32_16x16x32_bf16 v[224:227], v[48:51], v[252:255], v[224:227]
    ds_read_b64_tr_b16 v[100:101], v10 offset:14528
    v_mfma_f32_16x16x32_bf16 v[228:231], v[52:55], v[252:255], v[228:231]
    v_mfma_f32_16x16x32_bf16 v[232:235], v[56:59], v[252:255], v[232:235]
    ds_read_b64_tr_b16 v[102:103], v10 offset:16320
    v_mfma_f32_16x16x32_bf16 v[236:239], v[60:63], v[252:255], v[236:239]
    v_mfma_f32_16x16x32_bf16 v[240:243], v[64:67], v[252:255], v[240:243]
    v_mfma_f32_16x16x32_bf16 v[244:247], v[68:71], v[252:255], v[244:247]
    v_mfma_f32_16x16x32_bf16 v[248:251], v[72:75], v[252:255], v[248:251]
    s_waitcnt lgkmcnt(0)
    s_barrier
    s_add_u32 s17, s17, 1
    s_cmp_ge_u32 s17, s18
    s_cbranch_scc1 k1m_cfin
    v_mfma_f32_16x16x32_bf16 v[104:107], v[76:79], v[32:35], v[104:107]
    ds_read_b128 v[16:19], v12 offset:0
    v_mfma_f32_16x16x32_bf16 v[108:111], v[80:83], v[32:35], v[108:111]
    ds_read_b128 v[20:23], v12 offset:2048
    v_mfma_f32_16x16x32_bf16 v[112:115], v[84:87], v[32:35], v[112:115]
    v_mfma_f32_16x16x32_bf16 v[116:119], v[88:91], v[32:35], v[116:119]
    ds_read_b128 v[24:27], v12 offset:4096
    v_mfma_f32_16x16x32_bf16 v[120:123], v[92:95], v[32:35], v[120:123]
    v_mfma_f32_16x16x32_bf16 v[124:127], v[96:99], v[32:35], v[124:127]
    ds_read_b128 v[28:31], v12 offset:6144
    v_mfma_f32_16x16x32_bf16 v[128:131], v[100:103], v[32:35], v[128:131]
    v_mfma_f32_16x16x32_bf16 v[132:135], v[76:79], v[36:39], v[132:135]
    ds_read_b64_tr_b16 v[48:49], v14 offset:0
    v_mfma_f32_16x16x32_bf16 v[136:139], v[80:83], v[36:39], v[136:139]
    ds_read_b64_tr_b16 v[50:51], v14 offset:1792
    v_mfma_f32_16x16x32_bf16 v[140:143], v[84:87], v[36:39], v[140:143]
    v_mfma_f32_16x16x32_bf16 v[144:147], v[88:91], v[36:39], v[144:147]
    ds_read_b64_tr_b16 v[52:53], v15 offset:32
    v_mfma_f32_16x16x32_bf16 v[148:151], v[92:95], v[36:39], v[148:151]
    v_mfma_f32_16x16x32_bf16 v[152:155], v[96:99], v[36:39], v[152:155]
    ds_read_b64_tr_b16 v[54:55], v15 offset:1824
    v_mfma_f32_16x16x32_bf16 v[156:159], v[100:103], v[36:39], v[156:159]
    v_mfma_f32_16x16x32_bf16 v[160:163], v[76:79], v[40:43], v[160:163]
    ds_read_b64_tr_b16 v[56:57], v14 offset:64
    v_mfma_f32_16x16x32_bf16 v[164:167], v[80:83], v[40:43], v[164:167]
    v_mfma_f32_16x16x32_bf16 v[168:171], v[84:87], v[40:43], v[168:171]
    ds_read_b64_tr_b16 v[58:59], v14 offset:1856
    v_mfma_f32_16x16x32_bf16 v[172:175], v[88:91], v[40:43], v[172:175]
    ds_read_b64_tr_b16 v[60:61], v15 offset:96
    v_mfma_f32_16x16x32_bf16 v[176:179], v[92:95], v[40:43], v[176:179]
    v_mfma_f32_16x16x32_bf16 v[180:183], v[96:99], v[40:43], v[180:183]
    ds_read_b64_tr_b16 v[62:63], v15 offset:1888
    v_mfma_f32_16x16x32_bf16 v[184:187], v[100:103], v[40:43], v[184:187]
    v_mfma_f32_16x16x32_bf16 v[188:191], v[76:79], v[44:47], v[188:191]
    ds_read_b64_tr_b16 v[64:65], v14 offset:128
    v_mfma_f32_16x16x32_bf16 v[192:195], v[80:83], v[44:47], v[192:195]
    v_mfma_f32_16x16x32_bf16 v[196:199], v[84:87], v[44:47], v[196:199]
    ds_read_b64_tr_b16 v[66:67], v14 offset:1920
    v_mfma_f32_16x16x32_bf16 v[200:203], v[88:91], v[44:47], v[200:203]
    ds_read_b64_tr_b16 v[68:69], v15 offset:160
    v_mfma_f32_16x16x32_bf16 v[204:207], v[92:95], v[44:47], v[204:207]
    v_mfma_f32_16x16x32_bf16 v[208:211], v[96:99], v[44:47], v[208:211]
    ds_read_b64_tr_b16 v[70:71], v15 offset:1952
    v_mfma_f32_16x16x32_bf16 v[212:215], v[100:103], v[44:47], v[212:215]
    v_mfma_f32_16x16x32_bf16 v[224:227], v[76:79], v[252:255], v[224:227]
    ds_read_b64_tr_b16 v[72:73], v14 offset:192
    v_mfma_f32_16x16x32_bf16 v[228:231], v[80:83], v[252:255], v[228:231]
    v_mfma_f32_16x16x32_bf16 v[232:235], v[84:87], v[252:255], v[232:235]
    ds_read_b64_tr_b16 v[74:75], v14 offset:1984
    v_mfma_f32_16x16x32_bf16 v[236:239], v[88:91], v[252:255], v[236:239]
    v_mfma_f32_16x16x32_bf16 v[240:243], v[92:95], v[252:255], v[240:243]
    v_mfma_f32_16x16x32_bf16 v[244:247], v[96:99], v[252:255], v[244:247]
    v_mfma_f32_16x16x32_bf16 v[248:251], v[100:103], v[252:255], v[248:251]
    s_waitcnt lgkmcnt(0)
    v_mfma_f32_16x16x32_bf16 v[104:107], v[48:51], v[16:19], v[104:107]
    ds_read_b128 v[32:35], v13 offset:0
    v_mfma_f32_16x16x32_bf16 v[108:111], v[52:55], v[16:19], v[108:111]
    ds_read_b128 v[36:39], v13 offset:2048
    v_mfma_f32_16x16x32_bf16 v[112:115], v[56:59], v[16:19], v[112:115]
    v_mfma_f32_16x16x32_bf16 v[116:119], v[60:63], v[16:19], v[116:119]
    ds_read_b128 v[40:43], v13 offset:4096
    v_mfma_f32_16x16x32_bf16 v[120:123], v[64:67], v[16:19], v[120:123]
    v_mfma_f32_16x16x32_bf16 v[124:127], v[68:71], v[16:19], v[124:127]
    ds_read_b128 v[44:47], v13 offset:6144
    v_mfma_f32_16x16x32_bf16 v[128:131], v[72:75], v[16:19], v[128:131]
    v_mfma_f32_16x16x32_bf16 v[132:135], v[48:51], v[20:23], v[132:135]
    ds_read_b64_tr_b16 v[76:77], v14 offset:14336
    v_mfma_f32_16x16x32_bf16 v[136:139], v[52:55], v[20:23], v[136:139]
    ds_read_b64_tr_b16 v[78:79], v14 offset:16128
    v_mfma_f32_16x16x32_bf16 v[140:143], v[56:59], v[20:23], v[140:143]
    v_mfma_f32_16x16x32_bf16 v[144:147], v[60:63], v[20:23], v[144:147]
    ds_read_b64_tr_b16 v[80:81], v15 offset:14368
    v_mfma_f32_16x16x32_bf16 v[148:151], v[64:67], v[20:23], v[148:151]
    v_mfma_f32_16x16x32_bf16 v[152:155], v[68:71], v[20:23], v[152:155]
    ds_read_b64_tr_b16 v[82:83], v15 offset:16160
    v_mfma_f32_16x16x32_bf16 v[156:159], v[72:75], v[20:23], v[156:159]
    v_mfma_f32_16x16x32_bf16 v[160:163], v[48:51], v[24:27], v[160:163]
    ds_read_b64_tr_b16 v[84:85], v14 offset:14400
    v_mfma_f32_16x16x32_bf16 v[164:167], v[52:55], v[24:27], v[164:167]
    v_mfma_f32_16x16x32_bf16 v[168:171], v[56:59], v[24:27], v[168:171]
    ds_read_b64_tr_b16 v[86:87], v14 offset:16192
    v_mfma_f32_16x16x32_bf16 v[172:175], v[60:63], v[24:27], v[172:175]
    ds_read_b64_tr_b16 v[88:89], v15 offset:14432
    v_mfma_f32_16x16x32_bf16 v[176:179], v[64:67], v[24:27], v[176:179]
    v_mfma_f32_16x16x32_bf16 v[180:183], v[68:71], v[24:27], v[180:183]
    ds_read_b64_tr_b16 v[90:91], v15 offset:16224
    v_mfma_f32_16x16x32_bf16 v[184:187], v[72:75], v[24:27], v[184:187]
    v_mfma_f32_16x16x32_bf16 v[188:191], v[48:51], v[28:31], v[188:191]
    ds_read_b64_tr_b16 v[92:93], v14 offset:14464
    v_mfma_f32_16x16x32_bf16 v[192:195], v[52:55], v[28:31], v[192:195]
    v_mfma_f32_16x16x32_bf16 v[196:199], v[56:59], v[28:31], v[196:199]
    ds_read_b64_tr_b16 v[94:95], v14 offset:16256
    v_mfma_f32_16x16x32_bf16 v[200:203], v[60:63], v[28:31], v[200:203]
    ds_read_b64_tr_b16 v[96:97], v15 offset:14496
    v_mfma_f32_16x16x32_bf16 v[204:207], v[64:67], v[28:31], v[204:207]
    v_mfma_f32_16x16x32_bf16 v[208:211], v[68:71], v[28:31], v[208:211]
    ds_read_b64_tr_b16 v[98:99], v15 offset:16288
    v_mfma_f32_16x16x32_bf16 v[212:215], v[72:75], v[28:31], v[212:215]
    v_mfma_f32_16x16x32_bf16 v[224:227], v[48:51], v[252:255], v[224:227]
    ds_read_b64_tr_b16 v[100:101], v14 offset:14528
    v_mfma_f32_16x16x32_bf16 v[228:231], v[52:55], v[252:255], v[228:231]
    v_mfma_f32_16x16x32_bf16 v[232:235], v[56:59], v[252:255], v[232:235]
    ds_read_b64_tr_b16 v[102:103], v14 offset:16320
    v_mfma_f32_16x16x32_bf16 v[236:239], v[60:63], v[252:255], v[236:239]
    v_mfma_f32_16x16x32_bf16 v[240:243], v[64:67], v[252:255], v[240:243]
    v_mfma_f32_16x16x32_bf16 v[244:247], v[68:71], v[252:255], v[244:247]
    v_mfma_f32_16x16x32_bf16 v[248:251], v[72:75], v[252:255], v[248:251]
    s_waitcnt lgkmcnt(0)
    s_barrier
    s_add_u32 s17, s17, 1
    s_cmp_ge_u32 s17, s18
    s_cbranch_scc1 k1m_cfin
    v_mfma_f32_16x16x32_bf16 v[104:107], v[76:79], v[32:35], v[104:107]
    ds_read_b128 v[16:19], v4 offset:0
    v_mfma_f32_16x16x32_bf16 v[108:111], v[80:83], v[32:35], v[108:111]
    ds_read_b128 v[20:23], v4 offset:2048
    v_mfma_f32_16x16x32_bf16 v[112:115], v[84:87], v[32:35], v[112:115]
    v_mfma_f32_16x16x32_bf16 v[116:119], v[88:91], v[32:35], v[116:119]
    ds_read_b128 v[24:27], v4 offset:4096
    v_mfma_f32_16x16x32_bf16 v[120:123], v[92:95], v[32:35], v[120:123]
    v_mfma_f32_16x16x32_bf16 v[124:127], v[96:99], v[32:35], v[124:127]
    ds_read_b128 v[28:31], v4 offset:6144
    v_mfma_f32_16x16x32_bf16 v[128:131], v[100:103], v[32:35], v[128:131]
    v_mfma_f32_16x16x32_bf16 v[132:135], v[76:79], v[36:39], v[132:135]
    ds_read_b64_tr_b16 v[48:49], v6 offset:0
    v_mfma_f32_16x16x32_bf16 v[136:139], v[80:83], v[36:39], v[136:139]
    ds_read_b64_tr_b16 v[50:51], v6 offset:1792
    v_mfma_f32_16x16x32_bf16 v[140:143], v[84:87], v[36:39], v[140:143]
    v_mfma_f32_16x16x32_bf16 v[144:147], v[88:91], v[36:39], v[144:147]
    ds_read_b64_tr_b16 v[52:53], v7 offset:32
    v_mfma_f32_16x16x32_bf16 v[148:151], v[92:95], v[36:39], v[148:151]
    v_mfma_f32_16x16x32_bf16 v[152:155], v[96:99], v[36:39], v[152:155]
    ds_read_b64_tr_b16 v[54:55], v7 offset:1824
    v_mfma_f32_16x16x32_bf16 v[156:159], v[100:103], v[36:39], v[156:159]
    v_mfma_f32_16x16x32_bf16 v[160:163], v[76:79], v[40:43], v[160:163]
    ds_read_b64_tr_b16 v[56:57], v6 offset:64
    v_mfma_f32_16x16x32_bf16 v[164:167], v[80:83], v[40:43], v[164:167]
    v_mfma_f32_16x16x32_bf16 v[168:171], v[84:87], v[40:43], v[168:171]
    ds_read_b64_tr_b16 v[58:59], v6 offset:1856
    v_mfma_f32_16x16x32_bf16 v[172:175], v[88:91], v[40:43], v[172:175]
    ds_read_b64_tr_b16 v[60:61], v7 offset:96
    v_mfma_f32_16x16x32_bf16 v[176:179], v[92:95], v[40:43], v[176:179]
    v_mfma_f32_16x16x32_bf16 v[180:183], v[96:99], v[40:43], v[180:183]
    ds_read_b64_tr_b16 v[62:63], v7 offset:1888
    v_mfma_f32_16x16x32_bf16 v[184:187], v[100:103], v[40:43], v[184:187]
    v_mfma_f32_16x16x32_bf16 v[188:191], v[76:79], v[44:47], v[188:191]
    ds_read_b64_tr_b16 v[64:65], v6 offset:128
    v_mfma_f32_16x16x32_bf16 v[192:195], v[80:83], v[44:47], v[192:195]
    v_mfma_f32_16x16x32_bf16 v[196:199], v[84:87], v[44:47], v[196:199]
    ds_read_b64_tr_b16 v[66:67], v6 offset:1920
    v_mfma_f32_16x16x32_bf16 v[200:203], v[88:91], v[44:47], v[200:203]
    ds_read_b64_tr_b16 v[68:69], v7 offset:160
    v_mfma_f32_16x16x32_bf16 v[204:207], v[92:95], v[44:47], v[204:207]
    v_mfma_f32_16x16x32_bf16 v[208:211], v[96:99], v[44:47], v[208:211]
    ds_read_b64_tr_b16 v[70:71], v7 offset:1952
    v_mfma_f32_16x16x32_bf16 v[212:215], v[100:103], v[44:47], v[212:215]
    v_mfma_f32_16x16x32_bf16 v[224:227], v[76:79], v[252:255], v[224:227]
    ds_read_b64_tr_b16 v[72:73], v6 offset:192
    v_mfma_f32_16x16x32_bf16 v[228:231], v[80:83], v[252:255], v[228:231]
    v_mfma_f32_16x16x32_bf16 v[232:235], v[84:87], v[252:255], v[232:235]
    ds_read_b64_tr_b16 v[74:75], v6 offset:1984
    v_mfma_f32_16x16x32_bf16 v[236:239], v[88:91], v[252:255], v[236:239]
    v_mfma_f32_16x16x32_bf16 v[240:243], v[92:95], v[252:255], v[240:243]
    v_mfma_f32_16x16x32_bf16 v[244:247], v[96:99], v[252:255], v[244:247]
    v_mfma_f32_16x16x32_bf16 v[248:251], v[100:103], v[252:255], v[248:251]
    s_waitcnt lgkmcnt(0)
    v_mfma_f32_16x16x32_bf16 v[104:107], v[48:51], v[16:19], v[104:107]
    ds_read_b128 v[32:35], v5 offset:0
    v_mfma_f32_16x16x32_bf16 v[108:111], v[52:55], v[16:19], v[108:111]
    ds_read_b128 v[36:39], v5 offset:2048
    v_mfma_f32_16x16x32_bf16 v[112:115], v[56:59], v[16:19], v[112:115]
    v_mfma_f32_16x16x32_bf16 v[116:119], v[60:63], v[16:19], v[116:119]
    ds_read_b128 v[40:43], v5 offset:4096
    v_mfma_f32_16x16x32_bf16 v[120:123], v[64:67], v[16:19], v[120:123]
    v_mfma_f32_16x16x32_bf16 v[124:127], v[68:71], v[16:19], v[124:127]
    ds_read_b128 v[44:47], v5 offset:6144
    v_mfma_f32_16x16x32_bf16 v[128:131], v[72:75], v[16:19], v[128:131]
    v_mfma_f32_16x16x32_bf16 v[132:135], v[48:51], v[20:23], v[132:135]
    ds_read_b64_tr_b16 v[76:77], v6 offset:14336
    v_mfma_f32_16x16x32_bf16 v[136:139], v[52:55], v[20:23], v[136:139]
    ds_read_b64_tr_b16 v[78:79], v6 offset:16128
    v_mfma_f32_16x16x32_bf16 v[140:143], v[56:59], v[20:23], v[140:143]
    v_mfma_f32_16x16x32_bf16 v[144:147], v[60:63], v[20:23], v[144:147]
    ds_read_b64_tr_b16 v[80:81], v7 offset:14368
    v_mfma_f32_16x16x32_bf16 v[148:151], v[64:67], v[20:23], v[148:151]
    v_mfma_f32_16x16x32_bf16 v[152:155], v[68:71], v[20:23], v[152:155]
    ds_read_b64_tr_b16 v[82:83], v7 offset:16160
    v_mfma_f32_16x16x32_bf16 v[156:159], v[72:75], v[20:23], v[156:159]
    v_mfma_f32_16x16x32_bf16 v[160:163], v[48:51], v[24:27], v[160:163]
    ds_read_b64_tr_b16 v[84:85], v6 offset:14400
    v_mfma_f32_16x16x32_bf16 v[164:167], v[52:55], v[24:27], v[164:167]
    v_mfma_f32_16x16x32_bf16 v[168:171], v[56:59], v[24:27], v[168:171]
    ds_read_b64_tr_b16 v[86:87], v6 offset:16192
    v_mfma_f32_16x16x32_bf16 v[172:175], v[60:63], v[24:27], v[172:175]
    ds_read_b64_tr_b16 v[88:89], v7 offset:14432
    v_mfma_f32_16x16x32_bf16 v[176:179], v[64:67], v[24:27], v[176:179]
    v_mfma_f32_16x16x32_bf16 v[180:183], v[68:71], v[24:27], v[180:183]
    ds_read_b64_tr_b16 v[90:91], v7 offset:16224
    v_mfma_f32_16x16x32_bf16 v[184:187], v[72:75], v[24:27], v[184:187]
    v_mfma_f32_16x16x32_bf16 v[188:191], v[48:51], v[28:31], v[188:191]
    ds_read_b64_tr_b16 v[92:93], v6 offset:14464
    v_mfma_f32_16x16x32_bf16 v[192:195], v[52:55], v[28:31], v[192:195]
    v_mfma_f32_16x16x32_bf16 v[196:199], v[56:59], v[28:31], v[196:199]
    ds_read_b64_tr_b16 v[94:95], v6 offset:16256
    v_mfma_f32_16x16x32_bf16 v[200:203], v[60:63], v[28:31], v[200:203]
    ds_read_b64_tr_b16 v[96:97], v7 offset:14496
    v_mfma_f32_16x16x32_bf16 v[204:207], v[64:67], v[28:31], v[204:207]
    v_mfma_f32_16x16x32_bf16 v[208:211], v[68:71], v[28:31], v[208:211]
    ds_read_b64_tr_b16 v[98:99], v7 offset:16288
    v_mfma_f32_16x16x32_bf16 v[212:215], v[72:75], v[28:31], v[212:215]
    v_mfma_f32_16x16x32_bf16 v[224:227], v[48:51], v[252:255], v[224:227]
    ds_read_b64_tr_b16 v[100:101], v6 offset:14528
    v_mfma_f32_16x16x32_bf16 v[228:231], v[52:55], v[252:255], v[228:231]
    v_mfma_f32_16x16x32_bf16 v[232:235], v[56:59], v[252:255], v[232:235]
    ds_read_b64_tr_b16 v[102:103], v6 offset:16320
    v_mfma_f32_16x16x32_bf16 v[236:239], v[60:63], v[252:255], v[236:239]
    v_mfma_f32_16x16x32_bf16 v[240:243], v[64:67], v[252:255], v[240:243]
    v_mfma_f32_16x16x32_bf16 v[244:247], v[68:71], v[252:255], v[244:247]
    v_mfma_f32_16x16x32_bf16 v[248:251], v[72:75], v[252:255], v[248:251]
    s_waitcnt lgkmcnt(0)
    s_barrier
    s_add_u32 s17, s17, 1
    s_cmp_ge_u32 s17, s18
    s_cbranch_scc1 k1m_cfin
    s_branch k1m_cloop
k1m_cfin:
    v_mfma_f32_16x16x32_bf16 v[104:107], v[76:79], v[32:35], v[104:107]
    v_mfma_f32_16x16x32_bf16 v[108:111], v[80:83], v[32:35], v[108:111]
    v_mfma_f32_16x16x32_bf16 v[112:115], v[84:87], v[32:35], v[112:115]
    v_mfma_f32_16x16x32_bf16 v[116:119], v[88:91], v[32:35], v[116:119]
    v_mfma_f32_16x16x32_bf16 v[120:123], v[92:95], v[32:35], v[120:123]
    v_mfma_f32_16x16x32_bf16 v[124:127], v[96:99], v[32:35], v[124:127]
    v_mfma_f32_16x16x32_bf16 v[128:131], v[100:103], v[32:35], v[128:131]
    v_mfma_f32_16x16x32_bf16 v[132:135], v[76:79], v[36:39], v[132:135]
    v_mfma_f32_16x16x32_bf16 v[136:139], v[80:83], v[36:39], v[136:139]
    v_mfma_f32_16x16x32_bf16 v[140:143], v[84:87], v[36:39], v[140:143]
    v_mfma_f32_16x16x32_bf16 v[144:147], v[88:91], v[36:39], v[144:147]
    v_mfma_f32_16x16x32_bf16 v[148:151], v[92:95], v[36:39], v[148:151]
    v_mfma_f32_16x16x32_bf16 v[152:155], v[96:99], v[36:39], v[152:155]
    v_mfma_f32_16x16x32_bf16 v[156:159], v[100:103], v[36:39], v[156:159]
    v_mfma_f32_16x16x32_bf16 v[160:163], v[76:79], v[40:43], v[160:163]
    v_mfma_f32_16x16x32_bf16 v[164:167], v[80:83], v[40:43], v[164:167]
    v_mfma_f32_16x16x32_bf16 v[168:171], v[84:87], v[40:43], v[168:171]
    v_mfma_f32_16x16x32_bf16 v[172:175], v[88:91], v[40:43], v[172:175]
    v_mfma_f32_16x16x32_bf16 v[176:179], v[92:95], v[40:43], v[176:179]
    v_mfma_f32_16x16x32_bf16 v[180:183], v[96:99], v[40:43], v[180:183]
    v_mfma_f32_16x16x32_bf16 v[184:187], v[100:103], v[40:43], v[184:187]
    v_mfma_f32_16x16x32_bf16 v[188:191], v[76:79], v[44:47], v[188:191]
    v_mfma_f32_16x16x32_bf16 v[192:195], v[80:83], v[44:47], v[192:195]
    v_mfma_f32_16x16x32_bf16 v[196:199], v[84:87], v[44:47], v[196:199]
    v_mfma_f32_16x16x32_bf16 v[200:203], v[88:91], v[44:47], v[200:203]
    v_mfma_f32_16x16x32_bf16 v[204:207], v[92:95], v[44:47], v[204:207]
    v_mfma_f32_16x16x32_bf16 v[208:211], v[96:99], v[44:47], v[208:211]
    v_mfma_f32_16x16x32_bf16 v[212:215], v[100:103], v[44:47], v[212:215]
    v_mfma_f32_16x16x32_bf16 v[224:227], v[76:79], v[252:255], v[224:227]
    v_mfma_f32_16x16x32_bf16 v[228:231], v[80:83], v[252:255], v[228:231]
    v_mfma_f32_16x16x32_bf16 v[232:235], v[84:87], v[252:255], v[232:235]
    v_mfma_f32_16x16x32_bf16 v[236:239], v[88:91], v[252:255], v[236:239]
    v_mfma_f32_16x16x32_bf16 v[240:243], v[92:95], v[252:255], v[240:243]
    v_mfma_f32_16x16x32_bf16 v[244:247], v[96:99], v[252:255], v[244:247]
    v_mfma_f32_16x16x32_bf16 v[248:251], v[100:103], v[252:255], v[248:251]
    s_barrier
    s_nop 7
    s_nop 7
    s_branch k1m_cdone
k1m_loader:
    v_lshrrev_b32 v2, 3, v1
    v_and_b32 v3, 7, v1
    v_xor_b32 v3, v3, v2
    v_lshlrev_b32 v3, 4, v3
    s_mul_i32 s24, s16, 32
    s_add_u32 s24, s24, s46
    v_add_u32 v216, s24, v2
    s_mov_b32 s25, 1024
    v_mul_lo_u32 v216, v216, s25
    v_add_u32 v216, v216, v3
    v_add_u32 v4, 0, v216
    v_add_u32 v5, 7168, v216
    v_add_u32 v6, 14336, v216
    v_add_u32 v7, 21504, v216
    s_mul_i32 s24, s16, 448
    s_lshl_b32 s25, s47, 1
    v_add_u32 v216, s24, v1
    v_mul_u32_u24 v217, 2341, v216
    v_lshrrev_b32 v217, 16, v217
    v_mul_u32_u24 v218, 28, v217
    v_sub_u32 v218, v216, v218
    v_lshrrev_b32 v219, 2, v217
    v_and_b32 v219, 2, v219
    v_xor_b32 v218, v218, v219
    v_lshlrev_b32 v218, 4, v218
    v_mul_u32_u24 v217, 3584, v217
    v_add3_u32 v8, v217, v218, s25
    v_add_u32 v216, s24, v1
    v_add_u32 v216, 64, v216
    v_mul_u32_u24 v217, 2341, v216
    v_lshrrev_b32 v217, 16, v217
    v_mul_u32_u24 v218, 28, v217
    v_sub_u32 v218, v216, v218
    v_lshrrev_b32 v219, 2, v217
    v_and_b32 v219, 2, v219
    v_xor_b32 v218, v218, v219
    v_lshlrev_b32 v218, 4, v218
    v_mul_u32_u24 v217, 3584, v217
    v_add3_u32 v9, v217, v218, s25
    v_subrev_u32 v9, 1024, v9
    v_add_u32 v216, s24, v1
    v_add_u32 v216, 128, v216
    v_mul_u32_u24 v217, 2341, v216
    v_lshrrev_b32 v217, 16, v217
    v_mul_u32_u24 v218, 28, v217
    v_sub_u32 v218, v216, v218
    v_lshrrev_b32 v219, 2, v217
    v_and_b32 v219, 2, v219
    v_xor_b32 v218, v218, v219
    v_lshlrev_b32 v218, 4, v218
    v_mul_u32_u24 v217, 3584, v217
    v_add3_u32 v10, v217, v218, s25
    v_subrev_u32 v10, 2048, v10
    v_add_u32 v216, s24, v1
    v_add_u32 v216, 192, v216
    v_mul_u32_u24 v217, 2341, v216
    v_lshrrev_b32 v217, 16, v217
    v_mul_u32_u24 v218, 28, v217
    v_sub_u32 v218, v216, v218
    v_lshrrev_b32 v219, 2, v217
    v_and_b32 v219, 2, v219
    v_xor_b32 v218, v218, v219
    v_lshlrev_b32 v218, 4, v218
    v_mul_u32_u24 v217, 3584, v217
    v_add3_u32 v11, v217, v218, s25
    v_subrev_u32 v11, 3072, v11
    v_add_u32 v216, s24, v1
    v_add_u32 v216, 256, v216
    v_mul_u32_u24 v217, 2341, v216
    v_lshrrev_b32 v217, 16, v217
    v_mul_u32_u24 v218, 28, v217
    v_sub_u32 v218, v216, v218
    v_lshrrev_b32 v219, 2, v217
    v_and_b32 v219, 2, v219
    v_xor_b32 v218, v218, v219
    v_lshlrev_b32 v218, 4, v218
    v_mul_u32_u24 v217, 3584, v217
    v_add3_u32 v12, v217, v218, s25
    v_add_u32 v216, s24, v1
    v_add_u32 v216, 320, v216
    v_mul_u32_u24 v217, 2341, v216
    v_lshrrev_b32 v217, 16, v217
    v_mul_u32_u24 v218, 28, v217
    v_sub_u32 v218, v216, v218
    v_lshrrev_b32 v219, 2, v217
    v_and_b32 v219, 2, v219
    v_xor_b32 v218, v218, v219
    v_lshlrev_b32 v218, 4, v218
    v_mul_u32_u24 v217, 3584, v217
    v_add3_u32 v13, v217, v218, s25
    v_subrev_u32 v13, 1024, v13
    v_add_u32 v216, s24, v1
    v_add_u32 v216, 384, v216
    v_mul_u32_u24 v217, 2341, v216
    v_lshrrev_b32 v217, 16, v217
    v_mul_u32_u24 v218, 28, v217
    v_sub_u32 v218, v216, v218
    v_lshrrev_b32 v219, 2, v217
    v_and_b32 v219, 2, v219
    v_xor_b32 v218, v218, v219
    v_lshlrev_b32 v218, 4, v218
    v_mul_u32_u24 v217, 3584, v217
    v_add3_u32 v14, v217, v218, s25
    v_subrev_u32 v14, 2048, v14
    s_mul_i32 s22, s16, 4096
    s_mul_i32 s23, s16, 7168
    s_add_u32 s23, s23, 16384
    v_lshrrev_b32 v2, 1, v1
    s_lshl_b32 s24, s16, 5
    v_add_u32 v2, s24, v2
    v_and_b32 v3, 1, v1
    v_lshlrev_b32 v3, 6, v3
    v_lshl_add_u32 v3, v2, 7, v3
    v_lshrrev_b32 v2, 1, v2
    v_add_u32 v40, 0, v2
    v_and_b32 v40, 3, v40
    v_lshl_add_u32 v32, v40, 4, v3
    v_add_u32 v40, 1, v2
    v_and_b32 v40, 3, v40
    v_lshl_add_u32 v33, v40, 4, v3
    v_add_u32 v40, 2, v2
    v_and_b32 v40, 3, v40
    v_lshl_add_u32 v34, v40, 4, v3
    v_add_u32 v40, 3, v2
    v_and_b32 v40, 3, v40
    v_lshl_add_u32 v35, v40, 4, v3
    v_mov_b32 v40, 0
    v_mov_b32 v41, 0
    v_mov_b32 v42, 0
    v_mov_b32 v43, 0
    v_mov_b32 v46, 0x3f803f80
    s_mov_b32 s55, 0
    s_cmp_lg_u32 s16, 0
    s_cbranch_scc1 k1m_nb
    s_mov_b32 s12, s40
    s_and_b32 s13, s41, 0xffff
    s_mov_b32 s14, 3584
    s_mov_b32 s15, 0x00020000
    v_min_u32 v2, 55, v1
    v_lshlrev_b32 v3, 3, v2
    s_lshl_b32 s24, s47, 1
    v_add_u32 v3, s24, v3
    buffer_load_dwordx2 v[20:21], v3, s[12:15], 0 offen
    v_lshlrev_b32 v22, 4, v2
    v_add_u32 v22, 136192, v22
k1m_nb:
    s_mov_b32 s52, 0
    s_add_u32 s25, s19, s49
    s_cmp_ge_u32 s25, s54
    s_cselect_b32 s24, s51, 0
    s_sub_u32 s25, s25, s24
    s_lshl_b32 s20, s25, 7
    s_mul_i32 s21, s25, 229376
    s_add_u32 s19, s19, 1
    s_add_u32 s24, s22, s52
    s_add_u32 m0, s24, 0
    s_nop 0
    buffer_load_dwordx4 v4, s[4:7], s20 offen lds
    buffer_load_dwordx4 v5, s[4:7], s20 offen offset:1024 lds
    buffer_load_dwordx4 v6, s[4:7], s20 offen offset:2048 lds
    buffer_load_dwordx4 v7, s[4:7], s20 offen offset:3072 lds
    s_add_u32 s24, s23, s52
    s_add_u32 m0, s24, 0
    s_nop 0
    buffer_load_dwordx4 v8, s[8:11], s21 offen lds
    buffer_load_dwordx4 v9, s[8:11], s21 offen offset:1024 lds
    buffer_load_dwordx4 v10, s[8:11], s21 offen offset:2048 lds
    buffer_load_dwordx4 v11, s[8:11], s21 offen offset:3072 lds
    s_add_u32 m0, s24, 4096
    s_nop 0
    buffer_load_dwordx4 v12, s[8:11], s21 offen lds
    buffer_load_dwordx4 v13, s[8:11], s21 offen offset:1024 lds
    buffer_load_dwordx4 v14, s[8:11], s21 offen offset:2048 lds
    s_add_u32 s52, s52, 45056
    s_cmp_ge_u32 s52, 135168
    s_cselect_b32 s52, 0, s52
    s_add_u32 s25, s19, s49
    s_cmp_ge_u32 s25, s54
    s_cselect_b32 s24, s51, 0
    s_sub_u32 s25, s25, s24
    s_lshl_b32 s20, s25, 7
    s_mul_i32 s21, s25, 229376
    s_add_u32 s19, s19, 1
    s_add_u32 s24, s22, s52
    s_add_u32 m0, s24, 0
    s_nop 0
    buffer_load_dwordx4 v4, s[4:7], s20 offen lds
    buffer_load_dwordx4 v5, s[4:7], s20 offen offset:1024 lds
    buffer_load_dwordx4 v6, s[4:7], s20 offen offset:2048 lds
    buffer_load_dwordx4 v7, s[4:7], s20 offen offset:3072 lds
    s_add_u32 s24, s23, s52
    s_add_u32 m0, s24, 0
    s_nop 0
    buffer_load_dwordx4 v8, s[8:11], s21 offen lds
    buffer_load_dwordx4 v9, s[8:11], s21 offen offset:1024 lds
    buffer_load_dwordx4 v10, s[8:11], s21 offen offset:2048 lds
    buffer_load_dwordx4 v11, s[8:11], s21 offen offset:3072 lds
    s_add_u32 m0, s24, 4096
    s_nop 0
    buffer_load_dwordx4 v12, s[8:11], s21 offen lds
    buffer_load_dwordx4 v13, s[8:11], s21 offen offset:1024 lds
    buffer_load_dwordx4 v14, s[8:11], s21 offen offset:2048 lds
    s_add_u32 s52, s52, 45056
    s_cmp_ge_u32 s52, 135168
    s_cselect_b32 s52, 0, s52
    s_add_u32 s25, s19, s49
    s_cmp_ge_u32 s25, s54
    s_cselect_b32 s24, s51, 0
    s_sub_u32 s25, s25, s24
    s_lshl_b32 s20, s25, 7
    s_mul_i32 s21, s25, 229376
    s_add_u32 s19, s19, 1
    s_add_u32 s24, s22, s52
    s_add_u32 m0, s24, 0
    s_nop 0
    buffer_load_dwordx4 v4, s[4:7], s20 offen lds
    buffer_load_dwordx4 v5, s[4:7], s20 offen offset:1024 lds
    buffer_load_dwordx4 v6, s[4:7], s20 offen offset:2048 lds
    buffer_load_dwordx4 v7, s[4:7], s20 offen offset:3072 lds
    s_add_u32 s24, s23, s52
    s_add_u32 m0, s24, 0
    s_nop 0
    buffer_load_dwordx4 v8, s[8:11], s21 offen lds
    buffer_load_dwordx4 v9, s[8:11], s21 offen offset:1024 lds
    buffer_load_dwordx4 v10, s[8:11], s21 offen offset:2048 lds
    buffer_load_dwordx4 v11, s[8:11], s21 offen offset:3072 lds
    s_add_u32 m0, s24, 4096
    s_nop 0
    buffer_load_dwordx4 v12, s[8:11], s21 offen lds
    buffer_load_dwordx4 v13, s[8:11], s21 offen offset:1024 lds
    buffer_load_dwordx4 v14, s[8:11], s21 offen offset:2048 lds
    s_add_u32 s52, s52, 45056
    s_cmp_ge_u32 s52, 135168
    s_cselect_b32 s52, 0, s52
    s_waitcnt vmcnt(22)
    s_cmp_lg_u32 s16, 0
    s_cbranch_scc1 k1m_nb2
    v_lshlrev_b32 v24, 16, v20
    v_and_b32 v25, 0xffff0000, v20
    v_lshlrev_b32 v26, 16, v21
    v_and_b32 v27, 0xffff0000, v21
    ds_write_b128 v22, v[24:27]
    s_waitcnt lgkmcnt(0)
k1m_nb2:
    s_barrier
    v_add_u32 v112, s55, v32
    ds_read_b128 v[64:67], v112
    v_add_u32 v113, s55, v33
    ds_read_b128 v[68:71], v113
    v_add_u32 v114, s55, v34
    ds_read_b128 v[72:75], v114
    v_add_u32 v115, s55, v35
    ds_read_b128 v[76:79], v115
    s_waitcnt lgkmcnt(3)
    v_dot2_f32_bf16 v40, v64, v46, v40
    v_dot2_f32_bf16 v42, v64, v64, v42
    v_dot2_f32_bf16 v41, v65, v46, v41
    v_dot2_f32_bf16 v43, v65, v65, v43
    v_dot2_f32_bf16 v40, v66, v46, v40
    v_dot2_f32_bf16 v42, v66, v66, v42
    v_dot2_f32_bf16 v41, v67, v46, v41
    v_dot2_f32_bf16 v43, v67, v67, v43
    s_waitcnt lgkmcnt(2)
    v_dot2_f32_bf16 v40, v68, v46, v40
    v_dot2_f32_bf16 v42, v68, v68, v42
    v_dot2_f32_bf16 v41, v69, v46, v41
    v_dot2_f32_bf16 v43, v69, v69, v43
    v_dot2_f32_bf16 v40, v70, v46, v40
    v_dot2_f32_bf16 v42, v70, v70, v42
    v_dot2_f32_bf16 v41, v71, v46, v41
    v_dot2_f32_bf16 v43, v71, v71, v43
    s_waitcnt lgkmcnt(1)
    v_dot2_f32_bf16 v40, v72, v46, v40
    v_dot2_f32_bf16 v42, v72, v72, v42
    v_dot2_f32_bf16 v41, v73, v46, v41
    v_dot2_f32_bf16 v43, v73, v73, v43
    v_dot2_f32_bf16 v40, v74, v46, v40
    v_dot2_f32_bf16 v42, v74, v74, v42
    v_dot2_f32_bf16 v41, v75, v46, v41
    v_dot2_f32_bf16 v43, v75, v75, v43
    s_waitcnt lgkmcnt(0)
    v_dot2_f32_bf16 v40, v76, v46, v40
    v_dot2_f32_bf16 v42, v76, v76, v42
    v_dot2_f32_bf16 v41, v77, v46, v41
    v_dot2_f32_bf16 v43, v77, v77, v43
    v_dot2_f32_bf16 v40, v78, v46, v40
    v_dot2_f32_bf16 v42, v78, v78, v42
    v_dot2_f32_bf16 v41, v79, v46, v41
    v_dot2_f32_bf16 v43, v79, v79, v43
    s_add_u32 s55, s55, 45056
    s_cmp_ge_u32 s55, 135168
    s_cselect_b32 s55, 0, s55
    s_waitcnt vmcnt(11)
    s_barrier
    s_sub_u32 s50, s18, 1
k1m_lloop:
    s_cmp_ge_u32 s19, s18
    s_cbranch_scc1 k1m_lnd
    s_add_u32 s25, s19, s49
    s_cmp_ge_u32 s25, s54
    s_cselect_b32 s24, s51, 0
    s_sub_u32 s25, s25, s24
    s_lshl_b32 s20, s25, 7
    s_mul_i32 s21, s25, 229376
    s_add_u32 s19, s19, 1
    s_add_u32 s24, s22, s52
    s_add_u32 m0, s24, 0
    s_nop 0
    buffer_load_dwordx4 v4, s[4:7], s20 offen lds
    buffer_load_dwordx4 v5, s[4:7], s20 offen offset:1024 lds
    buffer_load_dwordx4 v6, s[4:7], s20 offen offset:2048 lds
    buffer_load_dwordx4 v7, s[4:7], s20 offen offset:3072 lds
    s_add_u32 s24, s23, s52
    s_add_u32 m0, s24, 0
    s_nop 0
    buffer_load_dwordx4 v8, s[8:11], s21 offen lds
    buffer_load_dwordx4 v9, s[8:11], s21 offen offset:1024 lds
    buffer_load_dwordx4 v10, s[8:11], s21 offen offset:2048 lds
    buffer_load_dwordx4 v11, s[8:11], s21 offen offset:3072 lds
    s_add_u32 m0, s24, 4096
    s_nop 0
    buffer_load_dwordx4 v12, s[8:11], s21 offen lds
    buffer_load_dwordx4 v13, s[8:11], s21 offen offset:1024 lds
    buffer_load_dwordx4 v14, s[8:11], s21 offen offset:2048 lds
    s_add_u32 s52, s52, 45056
    s_cmp_ge_u32 s52, 135168
    s_cselect_b32 s52, 0, s52
    v_add_u32 v112, s55, v32
    ds_read_b128 v[64:67], v112
    v_add_u32 v113, s55, v33
    ds_read_b128 v[68:71], v113
    v_add_u32 v114, s55, v34
    ds_read_b128 v[72:75], v114
    v_add_u32 v115, s55, v35
    ds_read_b128 v[76:79], v115
    s_waitcnt lgkmcnt(3)
    v_dot2_f32_bf16 v40, v64, v46, v40
    v_dot2_f32_bf16 v42, v64, v64, v42
    v_dot2_f32_bf16 v41, v65, v46, v41
    v_dot2_f32_bf16 v43, v65, v65, v43
    v_dot2_f32_bf16 v40, v66, v46, v40
    v_dot2_f32_bf16 v42, v66, v66, v42
    v_dot2_f32_bf16 v41, v67, v46, v41
    v_dot2_f32_bf16 v43, v67, v67, v43
    s_waitcnt lgkmcnt(2)
    v_dot2_f32_bf16 v40, v68, v46, v40
    v_dot2_f32_bf16 v42, v68, v68, v42
    v_dot2_f32_bf16 v41, v69, v46, v41
    v_dot2_f32_bf16 v43, v69, v69, v43
    v_dot2_f32_bf16 v40, v70, v46, v40
    v_dot2_f32_bf16 v42, v70, v70, v42
    v_dot2_f32_bf16 v41, v71, v46, v41
    v_dot2_f32_bf16 v43, v71, v71, v43
    s_waitcnt lgkmcnt(1)
    v_dot2_f32_bf16 v40, v72, v46, v40
    v_dot2_f32_bf16 v42, v72, v72, v42
    v_dot2_f32_bf16 v41, v73, v46, v41
    v_dot2_f32_bf16 v43, v73, v73, v43
    v_dot2_f32_bf16 v40, v74, v46, v40
    v_dot2_f32_bf16 v42, v74, v74, v42
    v_dot2_f32_bf16 v41, v75, v46, v41
    v_dot2_f32_bf16 v43, v75, v75, v43
    s_waitcnt lgkmcnt(0)
    v_dot2_f32_bf16 v40, v76, v46, v40
    v_dot2_f32_bf16 v42, v76, v76, v42
    v_dot2_f32_bf16 v41, v77, v46, v41
    v_dot2_f32_bf16 v43, v77, v77, v43
    v_dot2_f32_bf16 v40, v78, v46, v40
    v_dot2_f32_bf16 v42, v78, v78, v42
    v_dot2_f32_bf16 v41, v79, v46, v41
    v_dot2_f32_bf16 v43, v79, v79, v43
    s_add_u32 s55, s55, 45056
    s_cmp_ge_u32 s55, 135168
    s_cselect_b32 s55, 0, s55
    s_waitcnt vmcnt(11)
    s_branch k1m_lbar
k1m_lnd:
    v_add_u32 v112, s55, v32
    ds_read_b128 v[64:67], v112
    v_add_u32 v113, s55, v33
    ds_read_b128 v[68:71], v113
    v_add_u32 v114, s55, v34
    ds_read_b128 v[72:75], v114
    v_add_u32 v115, s55, v35
    ds_read_b128 v[76:79], v115
    s_waitcnt lgkmcnt(3)
    v_dot2_f32_bf16 v40, v64, v46, v40
    v_dot2_f32_bf16 v42, v64, v64, v42
    v_dot2_f32_bf16 v41, v65, v46, v41
    v_dot2_f32_bf16 v43, v65, v65, v43
    v_dot2_f32_bf16 v40, v66, v46, v40
    v_dot2_f32_bf16 v42, v66, v66, v42
    v_dot2_f32_bf16 v41, v67, v46, v41
    v_dot2_f32_bf16 v43, v67, v67, v43
    s_waitcnt lgkmcnt(2)
    v_dot2_f32_bf16 v40, v68, v46, v40
    v_dot2_f32_bf16 v42, v68, v68, v42
    v_dot2_f32_bf16 v41, v69, v46, v41
    v_dot2_f32_bf16 v43, v69, v69, v43
    v_dot2_f32_bf16 v40, v70, v46, v40
    v_dot2_f32_bf16 v42, v70, v70, v42
    v_dot2_f32_bf16 v41, v71, v46, v41
    v_dot2_f32_bf16 v43, v71, v71, v43
    s_waitcnt lgkmcnt(1)
    v_dot2_f32_bf16 v40, v72, v46, v40
    v_dot2_f32_bf16 v42, v72, v72, v42
    v_dot2_f32_bf16 v41, v73, v46, v41
    v_dot2_f32_bf16 v43, v73, v73, v43
    v_dot2_f32_bf16 v40, v74, v46, v40
    v_dot2_f32_bf16 v42, v74, v74, v42
    v_dot2_f32_bf16 v41, v75, v46, v41
    v_dot2_f32_bf16 v43, v75, v75, v43
    s_waitcnt lgkmcnt(0)
    v_dot2_f32_bf16 v40, v76, v46, v40
    v_dot2_f32_bf16 v42, v76, v76, v42
    v_dot2_f32_bf16 v41, v77, v46, v41
    v_dot2_f32_bf16 v43, v77, v77, v43
    v_dot2_f32_bf16 v40, v78, v46, v40
    v_dot2_f32_bf16 v42, v78, v78, v42
    v_dot2_f32_bf16 v41, v79, v46, v41
    v_dot2_f32_bf16 v43, v79, v79, v43
    s_add_u32 s55, s55, 45056
    s_cmp_ge_u32 s55, 135168
    s_cselect_b32 s55, 0, s55
    s_waitcnt vmcnt(0)
k1m_lbar:
    s_barrier
    s_add_u32 s17, s17, 1
    s_cmp_lt_u32 s17, s50
    s_cbranch_scc1 k1m_lloop
    s_nop 3
    v_add_f32 v40, v40, v41
    v_add_f32 v42, v42, v43
    s_nop 1
    v_add_f32_dpp v40, v40, v40 quad_perm:[1,0,3,2] row_mask:0xf bank_mask:0xf
    v_add_f32_dpp v42, v42, v42 quad_perm:[1,0,3,2] row_mask:0xf bank_mask:0xf
    v_mul_f32 v40, 0x3b000000, v40
    v_mul_f32 v42, 0x3b000000, v42
    v_fma_f32 v42, -v40, v40, v42
    v_max_f32 v42, 0, v42
    v_cvt_pk_bf16_f32 v40, v40, v40
    v_lshlrev_b32 v40, 16, v40
    v_cvt_pk_bf16_f32 v42, v42, v42
    v_lshlrev_b32 v42, 16, v42
    v_add_f32 v42, 0x3727c5ac, v42
    v_cvt_pk_bf16_f32 v42, v42, v42
    v_lshlrev_b32 v42, 16, v42
    v_sqrt_f32 v42, v42
    s_nop 0
    v_cvt_pk_bf16_f32 v42, v42, v42
    v_lshlrev_b32 v42, 16, v42
    v_rcp_f32 v42, v42
    v_lshrrev_b32 v2, 1, v1
    s_lshl_b32 s24, s16, 5
    v_add_u32 v2, s24, v2
    v_lshlrev_b32 v2, 2, v2
    v_add_u32 v2, 135168, v2
    ds_write_b32 v2, v40
    ds_write_b32 v2, v42 offset:512
    s_waitcnt lgkmcnt(0)
    s_barrier
    s_branch k1m_ldone
k1m_cdone:
    s_mov_b32 s8, s40
    s_and_b32 s9, s41, 0xffff
    s_mov_b32 s10, 3584
    s_mov_b32 s11, 0x00020000
    s_lshr_b32 s27, s16, 1
    s_and_b32 s28, s16, 1
    s_mul_i32 s29, s28, 224
    s_mul_i32 s30, s27, 29696
    v_and_b32 v2, 15, v1
    v_lshrrev_b32 v3, 4, v1
    v_lshlrev_b32 v3, 3, v3
    v_add_u32 v3, s29, v3
    v_mul_u32_u24 v2, 464, v2
    v_add3_u32 v2, v2, v3, s30
    s_lshl_b32 s31, s47, 1
    v_add_u32 v3, s31, v3
    v_lshrrev_b32 v217, 4, v1
    v_lshlrev_b32 v217, 4, v217
    s_mul_i32 s30, s28, 448
    s_add_u32 s30, s30, 136192
    v_add_u32 v217, s30, v217
    ds_read_b128 v[48:51], v217 offset:0
    ds_read_b128 v[52:55], v217 offset:64
    ds_read_b128 v[56:59], v217 offset:128
    ds_read_b128 v[60:63], v217 offset:192
    ds_read_b128 v[64:67], v217 offset:256
    ds_read_b128 v[68:71], v217 offset:320
    ds_read_b128 v[72:75], v217 offset:384
    v_and_b32 v216, 15, v1
    s_mul_i32 s30, s27, 256
    s_add_u32 s30, s30, 135168
    v_lshlrev_b32 v216, 2, v216
    v_add_u32 v216, s30, v216
    ds_read_b32 v32, v216 offset:0
    ds_read_b32 v36, v216 offset:512
    ds_read_b32 v33, v216 offset:64
    ds_read_b32 v37, v216 offset:576
    ds_read_b32 v34, v216 offset:128
    ds_read_b32 v38, v216 offset:640
    ds_read_b32 v35, v216 offset:192
    ds_read_b32 v39, v216 offset:704
    s_waitcnt lgkmcnt(0)
    v_fma_f32 v216, -v32, v224, v104
    v_fma_f32 v217, -v32, v225, v105
    v_fma_f32 v218, -v32, v226, v106
    v_fma_f32 v219, -v32, v227, v107
    v_fma_f32 v216, v216, v36, v48
    v_fma_f32 v217, v217, v36, v49
    v_fma_f32 v218, v218, v36, v50
    v_fma_f32 v219, v219, v36, v51
    v_max_f32 v216, 0, v216
    v_max_f32 v217, 0, v217
    v_max_f32 v218, 0, v218
    v_max_f32 v219, 0, v219
    v_mul_f32 v216, v216, v216
    v_mul_f32 v217, v217, v217
    v_mul_f32 v218, v218, v218
    v_mul_f32 v219, v219, v219
    v_cvt_pk_bf16_f32 v220, v216, v217
    v_cvt_pk_bf16_f32 v221, v218, v219
    ds_write_b64 v2, v[220:221] offset:0
    v_fma_f32 v216, -v32, v228, v108
    v_fma_f32 v217, -v32, v229, v109
    v_fma_f32 v218, -v32, v230, v110
    v_fma_f32 v219, -v32, v231, v111
    v_fma_f32 v216, v216, v36, v52
    v_fma_f32 v217, v217, v36, v53
    v_fma_f32 v218, v218, v36, v54
    v_fma_f32 v219, v219, v36, v55
    v_max_f32 v216, 0, v216
    v_max_f32 v217, 0, v217
    v_max_f32 v218, 0, v218
    v_max_f32 v219, 0, v219
    v_mul_f32 v216, v216, v216
    v_mul_f32 v217, v217, v217
    v_mul_f32 v218, v218, v218
    v_mul_f32 v219, v219, v219
    v_cvt_pk_bf16_f32 v222, v216, v217
    v_cvt_pk_bf16_f32 v223, v218, v219
    ds_write_b64 v2, v[222:223] offset:32
    v_fma_f32 v216, -v32, v232, v112
    v_fma_f32 v217, -v32, v233, v113
    v_fma_f32 v218, -v32, v234, v114
    v_fma_f32 v219, -v32, v235, v115
    v_fma_f32 v216, v216, v36, v56
    v_fma_f32 v217, v217, v36, v57
    v_fma_f32 v218, v218, v36, v58
    v_fma_f32 v219, v219, v36, v59
    v_max_f32 v216, 0, v216
    v_max_f32 v217, 0, v217
    v_max_f32 v218, 0, v218
    v_max_f32 v219, 0, v219
    v_mul_f32 v216, v216, v216
    v_mul_f32 v217, v217, v217
    v_mul_f32 v218, v218, v218
    v_mul_f32 v219, v219, v219
    v_cvt_pk_bf16_f32 v220, v216, v217
    v_cvt_pk_bf16_f32 v221, v218, v219
    ds_write_b64 v2, v[220:221] offset:64
    v_fma_f32 v216, -v32, v236, v116
    v_fma_f32 v217, -v32, v237, v117
    v_fma_f32 v218, -v32, v238, v118
    v_fma_f32 v219, -v32, v239, v119
    v_fma_f32 v216, v216, v36, v60
    v_fma_f32 v217, v217, v36, v61
    v_fma_f32 v218, v218, v36, v62
    v_fma_f32 v219, v219, v36, v63
    v_max_f32 v216, 0, v216
    v_max_f32 v217, 0, v217
    v_max_f32 v218, 0, v218
    v_max_f32 v219, 0, v219
    v_mul_f32 v216, v216, v216
    v_mul_f32 v217, v217, v217
    v_mul_f32 v218, v218, v218
    v_mul_f32 v219, v219, v219
    v_cvt_pk_bf16_f32 v222, v216, v217
    v_cvt_pk_bf16_f32 v223, v218, v219
    ds_write_b64 v2, v[222:223] offset:96
    v_fma_f32 v216, -v32, v240, v120
    v_fma_f32 v217, -v32, v241, v121
    v_fma_f32 v218, -v32, v242, v122
    v_fma_f32 v219, -v32, v243, v123
    v_fma_f32 v216, v216, v36, v64
    v_fma_f32 v217, v217, v36, v65
    v_fma_f32 v218, v218, v36, v66
    v_fma_f32 v219, v219, v36, v67
    v_max_f32 v216, 0, v216
    v_max_f32 v217, 0, v217
    v_max_f32 v218, 0, v218
    v_max_f32 v219, 0, v219
    v_mul_f32 v216, v216, v216
    v_mul_f32 v217, v217, v217
    v_mul_f32 v218, v218, v218
    v_mul_f32 v219, v219, v219
    v_cvt_pk_bf16_f32 v220, v216, v217
    v_cvt_pk_bf16_f32 v221, v218, v219
    ds_write_b64 v2, v[220:221] offset:128
    v_fma_f32 v216, -v32, v244, v124
    v_fma_f32 v217, -v32, v245, v125
    v_fma_f32 v218, -v32, v246, v126
    v_fma_f32 v219, -v32, v247, v127
    v_fma_f32 v216, v216, v36, v68
    v_fma_f32 v217, v217, v36, v69
    v_fma_f32 v218, v218, v36, v70
    v_fma_f32 v219, v219, v36, v71
    v_max_f32 v216, 0, v216
    v_max_f32 v217, 0, v217
    v_max_f32 v218, 0, v218
    v_max_f32 v219, 0, v219
    v_mul_f32 v216, v216, v216
    v_mul_f32 v217, v217, v217
    v_mul_f32 v218, v218, v218
    v_mul_f32 v219, v219, v219
    v_cvt_pk_bf16_f32 v222, v216, v217
    v_cvt_pk_bf16_f32 v223, v218, v219
    ds_write_b64 v2, v[222:223] offset:160
    v_fma_f32 v216, -v32, v248, v128
    v_fma_f32 v217, -v32, v249, v129
    v_fma_f32 v218, -v32, v250, v130
    v_fma_f32 v219, -v32, v251, v131
    v_fma_f32 v216, v216, v36, v72
    v_fma_f32 v217, v217, v36, v73
    v_fma_f32 v218, v218, v36, v74
    v_fma_f32 v219, v219, v36, v75
    v_max_f32 v216, 0, v216
    v_max_f32 v217, 0, v217
    v_max_f32 v218, 0, v218
    v_max_f32 v219, 0, v219
    v_mul_f32 v216, v216, v216
    v_mul_f32 v217, v217, v217
    v_mul_f32 v218, v218, v218
    v_mul_f32 v219, v219, v219
    v_cvt_pk_bf16_f32 v220, v216, v217
    v_cvt_pk_bf16_f32 v221, v218, v219
    ds_write_b64 v2, v[220:221] offset:192
    v_fma_f32 v216, -v33, v224, v132
    v_fma_f32 v217, -v33, v225, v133
    v_fma_f32 v218, -v33, v226, v134
    v_fma_f32 v219, -v33, v227, v135
    v_fma_f32 v216, v216, v37, v48
    v_fma_f32 v217, v217, v37, v49
    v_fma_f32 v218, v218, v37, v50
    v_fma_f32 v219, v219, v37, v51
    v_max_f32 v216, 0, v216
    v_max_f32 v217, 0, v217
    v_max_f32 v218, 0, v218
    v_max_f32 v219, 0, v219
    v_mul_f32 v216, v216, v216
    v_mul_f32 v217, v217, v217
    v_mul_f32 v218, v218, v218
    v_mul_f32 v219, v219, v219
    v_cvt_pk_bf16_f32 v220, v216, v217
    v_cvt_pk_bf16_f32 v221, v218, v219
    ds_write_b64 v2, v[220:221] offset:7424
    v_fma_f32 v216, -v33, v228, v136
    v_fma_f32 v217, -v33, v229, v137
    v_fma_f32 v218, -v33, v230, v138
    v_fma_f32 v219, -v33, v231, v139
    v_fma_f32 v216, v216, v37, v52
    v_fma_f32 v217, v217, v37, v53
    v_fma_f32 v218, v218, v37, v54
    v_fma_f32 v219, v219, v37, v55
    v_max_f32 v216, 0, v216
    v_max_f32 v217, 0, v217
    v_max_f32 v218, 0, v218
    v_max_f32 v219, 0, v219
    v_mul_f32 v216, v216, v216
    v_mul_f32 v217, v217, v217
    v_mul_f32 v218, v218, v218
    v_mul_f32 v219, v219, v219
    v_cvt_pk_bf16_f32 v222, v216, v217
    v_cvt_pk_bf16_f32 v223, v218, v219
    ds_write_b64 v2, v[222:223] offset:7456
    v_fma_f32 v216, -v33, v232, v140
    v_fma_f32 v217, -v33, v233, v141
    v_fma_f32 v218, -v33, v234, v142
    v_fma_f32 v219, -v33, v235, v143
    v_fma_f32 v216, v216, v37, v56
    v_fma_f32 v217, v217, v37, v57
    v_fma_f32 v218, v218, v37, v58
    v_fma_f32 v219, v219, v37, v59
    v_max_f32 v216, 0, v216
    v_max_f32 v217, 0, v217
    v_max_f32 v218, 0, v218
    v_max_f32 v219, 0, v219
    v_mul_f32 v216, v216, v216
    v_mul_f32 v217, v217, v217
    v_mul_f32 v218, v218, v218
    v_mul_f32 v219, v219, v219
    v_cvt_pk_bf16_f32 v220, v216, v217
    v_cvt_pk_bf16_f32 v221, v218, v219
    ds_write_b64 v2, v[220:221] offset:7488
    v_fma_f32 v216, -v33, v236, v144
    v_fma_f32 v217, -v33, v237, v145
    v_fma_f32 v218, -v33, v238, v146
    v_fma_f32 v219, -v33, v239, v147
    v_fma_f32 v216, v216, v37, v60
    v_fma_f32 v217, v217, v37, v61
    v_fma_f32 v218, v218, v37, v62
    v_fma_f32 v219, v219, v37, v63
    v_max_f32 v216, 0, v216
    v_max_f32 v217, 0, v217
    v_max_f32 v218, 0, v218
    v_max_f32 v219, 0, v219
    v_mul_f32 v216, v216, v216
    v_mul_f32 v217, v217, v217
    v_mul_f32 v218, v218, v218
    v_mul_f32 v219, v219, v219
    v_cvt_pk_bf16_f32 v222, v216, v217
    v_cvt_pk_bf16_f32 v223, v218, v219
    ds_write_b64 v2, v[222:223] offset:7520
    v_fma_f32 v216, -v33, v240, v148
    v_fma_f32 v217, -v33, v241, v149
    v_fma_f32 v218, -v33, v242, v150
    v_fma_f32 v219, -v33, v243, v151
    v_fma_f32 v216, v216, v37, v64
    v_fma_f32 v217, v217, v37, v65
    v_fma_f32 v218, v218, v37, v66
    v_fma_f32 v219, v219, v37, v67
    v_max_f32 v216, 0, v216
    v_max_f32 v217, 0, v217
    v_max_f32 v218, 0, v218
    v_max_f32 v219, 0, v219
    v_mul_f32 v216, v216, v216
    v_mul_f32 v217, v217, v217
    v_mul_f32 v218, v218, v218
    v_mul_f32 v219, v219, v219
    v_cvt_pk_bf16_f32 v220, v216, v217
    v_cvt_pk_bf16_f32 v221, v218, v219
    ds_write_b64 v2, v[220:221] offset:7552
    v_fma_f32 v216, -v33, v244, v152
    v_fma_f32 v217, -v33, v245, v153
    v_fma_f32 v218, -v33, v246, v154
    v_fma_f32 v219, -v33, v247, v155
    v_fma_f32 v216, v216, v37, v68
    v_fma_f32 v217, v217, v37, v69
    v_fma_f32 v218, v218, v37, v70
    v_fma_f32 v219, v219, v37, v71
    v_max_f32 v216, 0, v216
    v_max_f32 v217, 0, v217
    v_max_f32 v218, 0, v218
    v_max_f32 v219, 0, v219
    v_mul_f32 v216, v216, v216
    v_mul_f32 v217, v217, v217
    v_mul_f32 v218, v218, v218
    v_mul_f32 v219, v219, v219
    v_cvt_pk_bf16_f32 v222, v216, v217
    v_cvt_pk_bf16_f32 v223, v218, v219
    ds_write_b64 v2, v[222:223] offset:7584
    v_fma_f32 v216, -v33, v248, v156
    v_fma_f32 v217, -v33, v249, v157
    v_fma_f32 v218, -v33, v250, v158
    v_fma_f32 v219, -v33, v251, v159
    v_fma_f32 v216, v216, v37, v72
    v_fma_f32 v217, v217, v37, v73
    v_fma_f32 v218, v218, v37, v74
    v_fma_f32 v219, v219, v37, v75
    v_max_f32 v216, 0, v216
    v_max_f32 v217, 0, v217
    v_max_f32 v218, 0, v218
    v_max_f32 v219, 0, v219
    v_mul_f32 v216, v216, v216
    v_mul_f32 v217, v217, v217
    v_mul_f32 v218, v218, v218
    v_mul_f32 v219, v219, v219
    v_cvt_pk_bf16_f32 v220, v216, v217
    v_cvt_pk_bf16_f32 v221, v218, v219
    ds_write_b64 v2, v[220:221] offset:7616
    v_fma_f32 v216, -v34, v224, v160
    v_fma_f32 v217, -v34, v225, v161
    v_fma_f32 v218, -v34, v226, v162
    v_fma_f32 v219, -v34, v227, v163
    v_fma_f32 v216, v216, v38, v48
    v_fma_f32 v217, v217, v38, v49
    v_fma_f32 v218, v218, v38, v50
    v_fma_f32 v219, v219, v38, v51
    v_max_f32 v216, 0, v216
    v_max_f32 v217, 0, v217
    v_max_f32 v218, 0, v218
    v_max_f32 v219, 0, v219
    v_mul_f32 v216, v216, v216
    v_mul_f32 v217, v217, v217
    v_mul_f32 v218, v218, v218
    v_mul_f32 v219, v219, v219
    v_cvt_pk_bf16_f32 v220, v216, v217
    v_cvt_pk_bf16_f32 v221, v218, v219
    ds_write_b64 v2, v[220:221] offset:14848
    v_fma_f32 v216, -v34, v228, v164
    v_fma_f32 v217, -v34, v229, v165
    v_fma_f32 v218, -v34, v230, v166
    v_fma_f32 v219, -v34, v231, v167
    v_fma_f32 v216, v216, v38, v52
    v_fma_f32 v217, v217, v38, v53
    v_fma_f32 v218, v218, v38, v54
    v_fma_f32 v219, v219, v38, v55
    v_max_f32 v216, 0, v216
    v_max_f32 v217, 0, v217
    v_max_f32 v218, 0, v218
    v_max_f32 v219, 0, v219
    v_mul_f32 v216, v216, v216
    v_mul_f32 v217, v217, v217
    v_mul_f32 v218, v218, v218
    v_mul_f32 v219, v219, v219
    v_cvt_pk_bf16_f32 v222, v216, v217
    v_cvt_pk_bf16_f32 v223, v218, v219
    ds_write_b64 v2, v[222:223] offset:14880
    v_fma_f32 v216, -v34, v232, v168
    v_fma_f32 v217, -v34, v233, v169
    v_fma_f32 v218, -v34, v234, v170
    v_fma_f32 v219, -v34, v235, v171
    v_fma_f32 v216, v216, v38, v56
    v_fma_f32 v217, v217, v38, v57
    v_fma_f32 v218, v218, v38, v58
    v_fma_f32 v219, v219, v38, v59
    v_max_f32 v216, 0, v216
    v_max_f32 v217, 0, v217
    v_max_f32 v218, 0, v218
    v_max_f32 v219, 0, v219
    v_mul_f32 v216, v216, v216
    v_mul_f32 v217, v217, v217
    v_mul_f32 v218, v218, v218
    v_mul_f32 v219, v219, v219
    v_cvt_pk_bf16_f32 v220, v216, v217
    v_cvt_pk_bf16_f32 v221, v218, v219
    ds_write_b64 v2, v[220:221] offset:14912
    v_fma_f32 v216, -v34, v236, v172
    v_fma_f32 v217, -v34, v237, v173
    v_fma_f32 v218, -v34, v238, v174
    v_fma_f32 v219, -v34, v239, v175
    v_fma_f32 v216, v216, v38, v60
    v_fma_f32 v217, v217, v38, v61
    v_fma_f32 v218, v218, v38, v62
    v_fma_f32 v219, v219, v38, v63
    v_max_f32 v216, 0, v216
    v_max_f32 v217, 0, v217
    v_max_f32 v218, 0, v218
    v_max_f32 v219, 0, v219
    v_mul_f32 v216, v216, v216
    v_mul_f32 v217, v217, v217
    v_mul_f32 v218, v218, v218
    v_mul_f32 v219, v219, v219
    v_cvt_pk_bf16_f32 v222, v216, v217
    v_cvt_pk_bf16_f32 v223, v218, v219
    ds_write_b64 v2, v[222:223] offset:14944
    v_fma_f32 v216, -v34, v240, v176
    v_fma_f32 v217, -v34, v241, v177
    v_fma_f32 v218, -v34, v242, v178
    v_fma_f32 v219, -v34, v243, v179
    v_fma_f32 v216, v216, v38, v64
    v_fma_f32 v217, v217, v38, v65
    v_fma_f32 v218, v218, v38, v66
    v_fma_f32 v219, v219, v38, v67
    v_max_f32 v216, 0, v216
    v_max_f32 v217, 0, v217
    v_max_f32 v218, 0, v218
    v_max_f32 v219, 0, v219
    v_mul_f32 v216, v216, v216
    v_mul_f32 v217, v217, v217
    v_mul_f32 v218, v218, v218
    v_mul_f32 v219, v219, v219
    v_cvt_pk_bf16_f32 v220, v216, v217
    v_cvt_pk_bf16_f32 v221, v218, v219
    ds_write_b64 v2, v[220:221] offset:14976
    v_fma_f32 v216, -v34, v244, v180
    v_fma_f32 v217, -v34, v245, v181
    v_fma_f32 v218, -v34, v246, v182
    v_fma_f32 v219, -v34, v247, v183
    v_fma_f32 v216, v216, v38, v68
    v_fma_f32 v217, v217, v38, v69
    v_fma_f32 v218, v218, v38, v70
    v_fma_f32 v219, v219, v38, v71
    v_max_f32 v216, 0, v216
    v_max_f32 v217, 0, v217
    v_max_f32 v218, 0, v218
    v_max_f32 v219, 0, v219
    v_mul_f32 v216, v216, v216
    v_mul_f32 v217, v217, v217
    v_mul_f32 v218, v218, v218
    v_mul_f32 v219, v219, v219
    v_cvt_pk_bf16_f32 v222, v216, v217
    v_cvt_pk_bf16_f32 v223, v218, v219
    ds_write_b64 v2, v[222:223] offset:15008
    v_fma_f32 v216, -v34, v248, v184
    v_fma_f32 v217, -v34, v249, v185
    v_fma_f32 v218, -v34, v250, v186
    v_fma_f32 v219, -v34, v251, v187
    v_fma_f32 v216, v216, v38, v72
    v_fma_f32 v217, v217, v38, v73
    v_fma_f32 v218, v218, v38, v74
    v_fma_f32 v219, v219, v38, v75
    v_max_f32 v216, 0, v216
    v_max_f32 v217, 0, v217
    v_max_f32 v218, 0, v218
    v_max_f32 v219, 0, v219
    v_mul_f32 v216, v216, v216
    v_mul_f32 v217, v217, v217
    v_mul_f32 v218, v218, v218
    v_mul_f32 v219, v219, v219
    v_cvt_pk_bf16_f32 v220, v216, v217
    v_cvt_pk_bf16_f32 v221, v218, v219
    ds_write_b64 v2, v[220:221] offset:15040
    v_fma_f32 v216, -v35, v224, v188
    v_fma_f32 v217, -v35, v225, v189
    v_fma_f32 v218, -v35, v226, v190
    v_fma_f32 v219, -v35, v227, v191
    v_fma_f32 v216, v216, v39, v48
    v_fma_f32 v217, v217, v39, v49
    v_fma_f32 v218, v218, v39, v50
    v_fma_f32 v219, v219, v39, v51
    v_max_f32 v216, 0, v216
    v_max_f32 v217, 0, v217
    v_max_f32 v218, 0, v218
    v_max_f32 v219, 0, v219
    v_mul_f32 v216, v216, v216
    v_mul_f32 v217, v217, v217
    v_mul_f32 v218, v218, v218
    v_mul_f32 v219, v219, v219
    v_cvt_pk_bf16_f32 v220, v216, v217
    v_cvt_pk_bf16_f32 v221, v218, v219
    ds_write_b64 v2, v[220:221] offset:22272
    v_fma_f32 v216, -v35, v228, v192
    v_fma_f32 v217, -v35, v229, v193
    v_fma_f32 v218, -v35, v230, v194
    v_fma_f32 v219, -v35, v231, v195
    v_fma_f32 v216, v216, v39, v52
    v_fma_f32 v217, v217, v39, v53
    v_fma_f32 v218, v218, v39, v54
    v_fma_f32 v219, v219, v39, v55
    v_max_f32 v216, 0, v216
    v_max_f32 v217, 0, v217
    v_max_f32 v218, 0, v218
    v_max_f32 v219, 0, v219
    v_mul_f32 v216, v216, v216
    v_mul_f32 v217, v217, v217
    v_mul_f32 v218, v218, v218
    v_mul_f32 v219, v219, v219
    v_cvt_pk_bf16_f32 v222, v216, v217
    v_cvt_pk_bf16_f32 v223, v218, v219
    ds_write_b64 v2, v[222:223] offset:22304
    v_fma_f32 v216, -v35, v232, v196
    v_fma_f32 v217, -v35, v233, v197
    v_fma_f32 v218, -v35, v234, v198
    v_fma_f32 v219, -v35, v235, v199
    v_fma_f32 v216, v216, v39, v56
    v_fma_f32 v217, v217, v39, v57
    v_fma_f32 v218, v218, v39, v58
    v_fma_f32 v219, v219, v39, v59
    v_max_f32 v216, 0, v216
    v_max_f32 v217, 0, v217
    v_max_f32 v218, 0, v218
    v_max_f32 v219, 0, v219
    v_mul_f32 v216, v216, v216
    v_mul_f32 v217, v217, v217
    v_mul_f32 v218, v218, v218
    v_mul_f32 v219, v219, v219
    v_cvt_pk_bf16_f32 v220, v216, v217
    v_cvt_pk_bf16_f32 v221, v218, v219
    ds_write_b64 v2, v[220:221] offset:22336
    v_fma_f32 v216, -v35, v236, v200
    v_fma_f32 v217, -v35, v237, v201
    v_fma_f32 v218, -v35, v238, v202
    v_fma_f32 v219, -v35, v239, v203
    v_fma_f32 v216, v216, v39, v60
    v_fma_f32 v217, v217, v39, v61
    v_fma_f32 v218, v218, v39, v62
    v_fma_f32 v219, v219, v39, v63
    v_max_f32 v216, 0, v216
    v_max_f32 v217, 0, v217
    v_max_f32 v218, 0, v218
    v_max_f32 v219, 0, v219
    v_mul_f32 v216, v216, v216
    v_mul_f32 v217, v217, v217
    v_mul_f32 v218, v218, v218
    v_mul_f32 v219, v219, v219
    v_cvt_pk_bf16_f32 v222, v216, v217
    v_cvt_pk_bf16_f32 v223, v218, v219
    ds_write_b64 v2, v[222:223] offset:22368
    v_fma_f32 v216, -v35, v240, v204
    v_fma_f32 v217, -v35, v241, v205
    v_fma_f32 v218, -v35, v242, v206
    v_fma_f32 v219, -v35, v243, v207
    v_fma_f32 v216, v216, v39, v64
    v_fma_f32 v217, v217, v39, v65
    v_fma_f32 v218, v218, v39, v66
    v_fma_f32 v219, v219, v39, v67
    v_max_f32 v216, 0, v216
    v_max_f32 v217, 0, v217
    v_max_f32 v218, 0, v218
    v_max_f32 v219, 0, v219
    v_mul_f32 v216, v216, v216
    v_mul_f32 v217, v217, v217
    v_mul_f32 v218, v218, v218
    v_mul_f32 v219, v219, v219
    v_cvt_pk_bf16_f32 v220, v216, v217
    v_cvt_pk_bf16_f32 v221, v218, v219
    ds_write_b64 v2, v[220:221] offset:22400
    v_fma_f32 v216, -v35, v244, v208
    v_fma_f32 v217, -v35, v245, v209
    v_fma_f32 v218, -v35, v246, v210
    v_fma_f32 v219, -v35, v247, v211
    v_fma_f32 v216, v216, v39, v68
    v_fma_f32 v217, v217, v39, v69
    v_fma_f32 v218, v218, v39, v70
    v_fma_f32 v219, v219, v39, v71
    v_max_f32 v216, 0, v216
    v_max_f32 v217, 0, v217
    v_max_f32 v218, 0, v218
    v_max_f32 v219, 0, v219
    v_mul_f32 v216, v216, v216
    v_mul_f32 v217, v217, v217
    v_mul_f32 v218, v218, v218
    v_mul_f32 v219, v219, v219
    v_cvt_pk_bf16_f32 v222, v216, v217
    v_cvt_pk_bf16_f32 v223, v218, v219
    ds_write_b64 v2, v[222:223] offset:22432
    v_fma_f32 v216, -v35, v248, v212
    v_fma_f32 v217, -v35, v249, v213
    v_fma_f32 v218, -v35, v250, v214
    v_fma_f32 v219, -v35, v251, v215
    v_fma_f32 v216, v216, v39, v72
    v_fma_f32 v217, v217, v39, v73
    v_fma_f32 v218, v218, v39, v74
    v_fma_f32 v219, v219, v39, v75
    v_max_f32 v216, 0, v216
    v_max_f32 v217, 0, v217
    v_max_f32 v218, 0, v218
    v_max_f32 v219, 0, v219
    v_mul_f32 v216, v216, v216
    v_mul_f32 v217, v217, v217
    v_mul_f32 v218, v218, v218
    v_mul_f32 v219, v219, v219
    v_cvt_pk_bf16_f32 v220, v216, v217
    v_cvt_pk_bf16_f32 v221, v218, v219
    ds_write_b64 v2, v[220:221] offset:22464
    s_waitcnt lgkmcnt(0)
k1m_ldone:
    s_barrier
    s_add_u32 s12, s32, 8388608
    s_addc_u32 s13, s33, 0
    s_and_b32 s13, s13, 0xffff
    s_mov_b32 s14, 8388608
    s_mov_b32 s15, 0x00020000
    s_lshl_b32 s24, s46, 12
    s_lshl_b32 s25, s47, 1
    s_add_u32 s31, s24, s25
    v_add_u32 v4, 0, v0
    v_mul_u32_u24 v5, 2341, v4
    v_lshrrev_b32 v5, 16, v5
    v_mul_u32_u24 v6, 28, v5
    v_sub_u32 v6, v4, v6
    v_lshlrev_b32 v6, 4, v6
    v_mul_u32_u24 v7, 464, v5
    v_add_u32 v7, v7, v6
    ds_read_b128 v[8:11], v7
    s_mov_b32 s24, 4096
    v_mul_lo_u32 v5, v5, s24
    v_add_u32 v48, v5, v6
    v_add_u32 v4, 512, v0
    v_mul_u32_u24 v5, 2341, v4
    v_lshrrev_b32 v5, 16, v5
    v_mul_u32_u24 v6, 28, v5
    v_sub_u32 v6, v4, v6
    v_lshlrev_b32 v6, 4, v6
    v_mul_u32_u24 v7, 464, v5
    v_add_u32 v7, v7, v6
    ds_read_b128 v[12:15], v7
    s_mov_b32 s24, 4096
    v_mul_lo_u32 v5, v5, s24
    v_add_u32 v49, v5, v6
    v_add_u32 v4, 1024, v0
    v_mul_u32_u24 v5, 2341, v4
    v_lshrrev_b32 v5, 16, v5
    v_mul_u32_u24 v6, 28, v5
    v_sub_u32 v6, v4, v6
    v_lshlrev_b32 v6, 4, v6
    v_mul_u32_u24 v7, 464, v5
    v_add_u32 v7, v7, v6
    ds_read_b128 v[16:19], v7
    s_mov_b32 s24, 4096
    v_mul_lo_u32 v5, v5, s24
    v_add_u32 v50, v5, v6
    v_add_u32 v4, 1536, v0
    v_mul_u32_u24 v5, 2341, v4
    v_lshrrev_b32 v5, 16, v5
    v_mul_u32_u24 v6, 28, v5
    v_sub_u32 v6, v4, v6
    v_lshlrev_b32 v6, 4, v6
    v_mul_u32_u24 v7, 464, v5
    v_add_u32 v7, v7, v6
    ds_read_b128 v[20:23], v7
    s_mov_b32 s24, 4096
    v_mul_lo_u32 v5, v5, s24
    v_add_u32 v51, v5, v6
    v_add_u32 v4, 2048, v0
    v_mul_u32_u24 v5, 2341, v4
    v_lshrrev_b32 v5, 16, v5
    v_mul_u32_u24 v6, 28, v5
    v_sub_u32 v6, v4, v6
    v_lshlrev_b32 v6, 4, v6
    v_mul_u32_u24 v7, 464, v5
    v_add_u32 v7, v7, v6
    ds_read_b128 v[24:27], v7
    s_mov_b32 s24, 4096
    v_mul_lo_u32 v5, v5, s24
    v_add_u32 v52, v5, v6
    v_add_u32 v4, 2560, v0
    v_mul_u32_u24 v5, 2341, v4
    v_lshrrev_b32 v5, 16, v5
    v_mul_u32_u24 v6, 28, v5
    v_sub_u32 v6, v4, v6
    v_lshlrev_b32 v6, 4, v6
    v_mul_u32_u24 v7, 464, v5
    v_add_u32 v7, v7, v6
    ds_read_b128 v[28:31], v7
    s_mov_b32 s24, 4096
    v_mul_lo_u32 v5, v5, s24
    v_add_u32 v53, v5, v6
    v_add_u32 v4, 3072, v0
    v_mul_u32_u24 v5, 2341, v4
    v_lshrrev_b32 v5, 16, v5
    v_mul_u32_u24 v6, 28, v5
    v_sub_u32 v6, v4, v6
    v_lshlrev_b32 v6, 4, v6
    v_mul_u32_u24 v7, 464, v5
    v_add_u32 v7, v7, v6
    ds_read_b128 v[32:35], v7
    s_mov_b32 s24, 4096
    v_mul_lo_u32 v5, v5, s24
    v_add_u32 v54, v5, v6
    s_waitcnt lgkmcnt(6)
    buffer_store_dwordx4 v[8:11], v48, s[12:15], s31 offen
    s_waitcnt lgkmcnt(5)
    buffer_store_dwordx4 v[12:15], v49, s[12:15], s31 offen
    s_waitcnt lgkmcnt(4)
    buffer_store_dwordx4 v[16:19], v50, s[12:15], s31 offen
    s_waitcnt lgkmcnt(3)
    buffer_store_dwordx4 v[20:23], v51, s[12:15], s31 offen
    s_waitcnt lgkmcnt(2)
    buffer_store_dwordx4 v[24:27], v52, s[12:15], s31 offen
    s_waitcnt lgkmcnt(1)
    buffer_store_dwordx4 v[28:31], v53, s[12:15], s31 offen
    s_waitcnt lgkmcnt(0)
    buffer_store_dwordx4 v[32:35], v54, s[12:15], s31 offen
L_k1_end:
    s_endpgm
.globl gemm2_kernel
.p2align 8
.type gemm2_kernel,@function
gemm2_kernel:
    s_cmp_ge_u32 s2, 256
    s_cbranch_scc1 L_k2_end
    s_load_dwordx2 s[26:27], s[0:1], 8
    s_load_dwordx2 s[28:29], s[0:1], 16
    s_load_dwordx2 s[32:33], s[0:1], 96
    s_load_dwordx2 s[34:35], s[0:1], 88
    s_load_dwordx2 s[40:41], s[0:1], 0
    s_load_dwordx2 s[42:43], s[0:1], 72
    s_load_dwordx2 s[56:57], s[0:1], 80
    v_and_b32 v1, 63, v0
    v_lshrrev_b32 v2, 6, v0
    s_nop 0
    v_readfirstlane_b32 s16, v2
    s_lshr_b32 s53, s16, 2
    s_and_b32 s16, s16, 3
    s_and_b32 s44, s2, 7
    s_lshr_b32 s45, s2, 3
    s_lshr_b32 s46, s44, 1
    s_and_b32 s47, s44, 1
    s_lshl_b32 s47, s47, 3
    s_lshr_b32 s48, s45, 2
    s_add_u32 s47, s47, s48
    s_and_b32 s48, s45, 3
    s_lshl_b32 s47, s47, 7
    s_lshl_b32 s48, s48, 7
    s_mov_b32 s17, 0
    s_add_u32 s18, s17, 23
    s_mov_b32 s19, s17
    s_lshr_b32 s49, s45, 2
    s_mul_i32 s49, s49, 0
    s_and_b32 s50, s45, 3
    s_mul_i32 s50, s50, 0
    s_add_u32 s49, s49, s50
    s_cmp_ge_u32 s49, 23
    s_cselect_b32 s50, 23, 0
    s_sub_u32 s49, s49, s50
    s_mov_b32 s51, 23
    s_waitcnt lgkmcnt(0)
    s_add_u32 s30, s32, 8388608
    s_addc_u32 s31, s33, 0
    s_and_b32 s27, s27, 0xffff
    s_and_b32 s29, s29, 0xffff
    s_and_b32 s31, s31, 0xffff
    s_mov_b32 s4, s26
    s_and_b32 s5, s27, 0xffff
    s_mov_b32 s6, 8388608
    s_mov_b32 s7, 0x00020000
    s_add_u32 s8, s32, 2097152
    s_addc_u32 s9, s33, 0
    s_and_b32 s9, s9, 0xffff
    s_mov_b32 s10, 6029312
    s_mov_b32 s11, 0x00020000
    s_mov_b32 s54, s18
    s_cmp_lg_u32 s53, 0
    s_cbranch_scc1 k2_loader
    s_lshr_b32 s24, s16, 1
    s_and_b32 s25, s16, 1
    v_and_b32 v2, 15, v1
    v_lshrrev_b32 v3, 4, v1
    v_and_b32 v148, 7, v1
    v_xor_b32 v148, v148, v3
    v_lshlrev_b32 v148, 4, v148
    s_mul_i32 s12, s24, 8192
    v_lshl_add_u32 v149, v2, 7, v148
    v_add_u32 v149, s12, v149
    v_add_u32 v4, 0, v149
    v_xor_b32 v5, 64, v4
    v_add_u32 v8, 32768, v149
    v_xor_b32 v9, 64, v8
    v_add_u32 v12, 65536, v149
    v_xor_b32 v13, 64, v12
    v_add_u32 v16, 98304, v149
    v_xor_b32 v17, 64, v16
    s_mul_i32 s12, s25, 8192
    s_add_u32 s12, s12, 16384
    v_lshl_add_u32 v149, v2, 7, v148
    v_add_u32 v149, s12, v149
    v_add_u32 v6, 0, v149
    v_xor_b32 v7, 64, v6
    v_add_u32 v10, 32768, v149
    v_xor_b32 v11, 64, v10
    v_add_u32 v14, 65536, v149
    v_xor_b32 v15, 64, v14
    v_add_u32 v18, 98304, v149
    v_xor_b32 v19, 64, v18
    v_mov_b32 v84, 0
    v_mov_b32 v85, 0
    v_mov_b32 v86, 0
    v_mov_b32 v87, 0
    v_mov_b32 v88, 0
    v_mov_b32 v89, 0
    v_mov_b32 v90, 0
    v_mov_b32 v91, 0
    v_mov_b32 v92, 0
    v_mov_b32 v93, 0
    v_mov_b32 v94, 0
    v_mov_b32 v95, 0
    v_mov_b32 v96, 0
    v_mov_b32 v97, 0
    v_mov_b32 v98, 0
    v_mov_b32 v99, 0
    v_mov_b32 v100, 0
    v_mov_b32 v101, 0
    v_mov_b32 v102, 0
    v_mov_b32 v103, 0
    v_mov_b32 v104, 0
    v_mov_b32 v105, 0
    v_mov_b32 v106, 0
    v_mov_b32 v107, 0
    v_mov_b32 v108, 0
    v_mov_b32 v109, 0
    v_mov_b32 v110, 0
    v_mov_b32 v111, 0
    v_mov_b32 v112, 0
    v_mov_b32 v113, 0
    v_mov_b32 v114, 0
    v_mov_b32 v115, 0
    v_mov_b32 v116, 0
    v_mov_b32 v117, 0
    v_mov_b32 v118, 0
    v_mov_b32 v119, 0
    v_mov_b32 v120, 0
    v_mov_b32 v121, 0
    v_mov_b32 v122, 0
    v_mov_b32 v123, 0
    v_mov_b32 v124, 0
    v_mov_b32 v125, 0
    v_mov_b32 v126, 0
    v_mov_b32 v127, 0
    v_mov_b32 v128, 0
    v_mov_b32 v129, 0
    v_mov_b32 v130, 0
    v_mov_b32 v131, 0
    v_mov_b32 v132, 0
    v_mov_b32 v133, 0
    v_mov_b32 v134, 0
    v_mov_b32 v135, 0
    v_mov_b32 v136, 0
    v_mov_b32 v137, 0
    v_mov_b32 v138, 0
    v_mov_b32 v139, 0
    v_mov_b32 v140, 0
    v_mov_b32 v141, 0
    v_mov_b32 v142, 0
    v_mov_b32 v143, 0
    v_mov_b32 v144, 0
    v_mov_b32 v145, 0
    v_mov_b32 v146, 0
    v_mov_b32 v147, 0
    s_barrier
    ds_read_b128 v[20:23], v4 offset:0
    ds_read_b128 v[24:27], v4 offset:2048
    ds_read_b128 v[28:31], v4 offset:4096
    ds_read_b128 v[32:35], v4 offset:6144
    ds_read_b128 v[52:55], v6 offset:0
    ds_read_b128 v[56:59], v6 offset:2048
    ds_read_b128 v[60:63], v6 offset:4096
    ds_read_b128 v[64:67], v6 offset:6144
    s_waitcnt lgkmcnt(0)
    v_mfma_f32_16x16x32_bf16 v[84:87], v[52:55], v[20:23], v[84:87]
    ds_read_b128 v[36:39], v5 offset:0
    v_mfma_f32_16x16x32_bf16 v[88:91], v[56:59], v[20:23], v[88:91]
    ds_read_b128 v[40:43], v5 offset:2048
    v_mfma_f32_16x16x32_bf16 v[92:95], v[60:63], v[20:23], v[92:95]
    v_mfma_f32_16x16x32_bf16 v[96:99], v[64:67], v[20:23], v[96:99]
    ds_read_b128 v[44:47], v5 offset:4096
    v_mfma_f32_16x16x32_bf16 v[100:103], v[52:55], v[24:27], v[100:103]
    ds_read_b128 v[48:51], v5 offset:6144
    v_mfma_f32_16x16x32_bf16 v[104:107], v[56:59], v[24:27], v[104:107]
    v_mfma_f32_16x16x32_bf16 v[108:111], v[60:63], v[24:27], v[108:111]
    ds_read_b128 v[68:71], v7 offset:0
    v_mfma_f32_16x16x32_bf16 v[112:115], v[64:67], v[24:27], v[112:115]
    v_mfma_f32_16x16x32_bf16 v[116:119], v[52:55], v[28:31], v[116:119]
    ds_read_b128 v[72:75], v7 offset:2048
    v_mfma_f32_16x16x32_bf16 v[120:123], v[56:59], v[28:31], v[120:123]
    ds_read_b128 v[76:79], v7 offset:4096
    v_mfma_f32_16x16x32_bf16 v[124:127], v[60:63], v[28:31], v[124:127]
    v_mfma_f32_16x16x32_bf16 v[128:131], v[64:67], v[28:31], v[128:131]
    ds_read_b128 v[80:83], v7 offset:6144
    v_mfma_f32_16x16x32_bf16 v[132:135], v[52:55], v[32:35], v[132:135]
    v_mfma_f32_16x16x32_bf16 v[136:139], v[56:59], v[32:35], v[136:139]
    v_mfma_f32_16x16x32_bf16 v[140:143], v[60:63], v[32:35], v[140:143]
    v_mfma_f32_16x16x32_bf16 v[144:147], v[64:67], v[32:35], v[144:147]
    s_waitcnt lgkmcnt(0)
    s_barrier
    s_sub_u32 s18, s18, 1
k2_cloop:
    v_mfma_f32_16x16x32_bf16 v[84:87], v[68:71], v[36:39], v[84:87]
    ds_read_b128 v[20:23], v8 offset:0
    v_mfma_f32_16x16x32_bf16 v[88:91], v[72:75], v[36:39], v[88:91]
    ds_read_b128 v[24:27], v8 offset:2048
    v_mfma_f32_16x16x32_bf16 v[92:95], v[76:79], v[36:39], v[92:95]
    v_mfma_f32_16x16x32_bf16 v[96:99], v[80:83], v[36:39], v[96:99]
    ds_read_b128 v[28:31], v8 offset:4096
    v_mfma_f32_16x16x32_bf16 v[100:103], v[68:71], v[40:43], v[100:103]
    ds_read_b128 v[32:35], v8 offset:6144
    v_mfma_f32_16x16x32_bf16 v[104:107], v[72:75], v[40:43], v[104:107]
    v_mfma_f32_16x16x32_bf16 v[108:111], v[76:79], v[40:43], v[108:111]
    ds_read_b128 v[52:55], v10 offset:0
    v_mfma_f32_16x16x32_bf16 v[112:115], v[80:83], v[40:43], v[112:115]
    v_mfma_f32_16x16x32_bf16 v[116:119], v[68:71], v[44:47], v[116:119]
    ds_read_b128 v[56:59], v10 offset:2048
    v_mfma_f32_16x16x32_bf16 v[120:123], v[72:75], v[44:47], v[120:123]
    ds_read_b128 v[60:63], v10 offset:4096
    v_mfma_f32_16x16x32_bf16 v[124:127], v[76:79], v[44:47], v[124:127]
    v_mfma_f32_16x16x32_bf16 v[128:131], v[80:83], v[44:47], v[128:131]
    ds_read_b128 v[64:67], v10 offset:6144
    v_mfma_f32_16x16x32_bf16 v[132:135], v[68:71], v[48:51], v[132:135]
    v_mfma_f32_16x16x32_bf16 v[136:139], v[72:75], v[48:51], v[136:139]
    v_mfma_f32_16x16x32_bf16 v[140:143], v[76:79], v[48:51], v[140:143]
    v_mfma_f32_16x16x32_bf16 v[144:147], v[80:83], v[48:51], v[144:147]
    s_waitcnt lgkmcnt(0)
    v_mfma_f32_16x16x32_bf16 v[84:87], v[52:55], v[20:23], v[84:87]
    ds_read_b128 v[36:39], v9 offset:0
    v_mfma_f32_16x16x32_bf16 v[88:91], v[56:59], v[20:23], v[88:91]
    ds_read_b128 v[40:43], v9 offset:2048
    v_mfma_f32_16x16x32_bf16 v[92:95], v[60:63], v[20:23], v[92:95]
    v_mfma_f32_16x16x32_bf16 v[96:99], v[64:67], v[20:23], v[96:99]
    ds_read_b128 v[44:47], v9 offset:4096
    v_mfma_f32_16x16x32_bf16 v[100:103], v[52:55], v[24:27], v[100:103]
    ds_read_b128 v[48:51], v9 offset:6144
    v_mfma_f32_16x16x32_bf16 v[104:107], v[56:59], v[24:27], v[104:107]
    v_mfma_f32_16x16x32_bf16 v[108:111], v[60:63], v[24:27], v[108:111]
    ds_read_b128 v[68:71], v11 offset:0
    v_mfma_f32_16x16x32_bf16 v[112:115], v[64:67], v[24:27], v[112:115]
    v_mfma_f32_16x16x32_bf16 v[116:119], v[52:55], v[28:31], v[116:119]
    ds_read_b128 v[72:75], v11 offset:2048
    v_mfma_f32_16x16x32_bf16 v[120:123], v[56:59], v[28:31], v[120:123]
    ds_read_b128 v[76:79], v11 offset:4096
    v_mfma_f32_16x16x32_bf16 v[124:127], v[60:63], v[28:31], v[124:127]
    v_mfma_f32_16x16x32_bf16 v[128:131], v[64:67], v[28:31], v[128:131]
    ds_read_b128 v[80:83], v11 offset:6144
    v_mfma_f32_16x16x32_bf16 v[132:135], v[52:55], v[32:35], v[132:135]
    v_mfma_f32_16x16x32_bf16 v[136:139], v[56:59], v[32:35], v[136:139]
    v_mfma_f32_16x16x32_bf16 v[140:143], v[60:63], v[32:35], v[140:143]
    v_mfma_f32_16x16x32_bf16 v[144:147], v[64:67], v[32:35], v[144:147]
    s_waitcnt lgkmcnt(0)
    s_barrier
    s_add_u32 s17, s17, 1
    s_cmp_ge_u32 s17, s18
    s_cbranch_scc1 k2_cfin
    v_mfma_f32_16x16x32_bf16 v[84:87], v[68:71], v[36:39], v[84:87]
    ds_read_b128 v[20:23], v12 offset:0
    v_mfma_f32_16x16x32_bf16 v[88:91], v[72:75], v[36:39], v[88:91]
    ds_read_b128 v[24:27], v12 offset:2048
    v_mfma_f32_16x16x32_bf16 v[92:95], v[76:79], v[36:39], v[92:95]
    v_mfma_f32_16x16x32_bf16 v[96:99], v[80:83], v[36:39], v[96:99]
    ds_read_b128 v[28:31], v12 offset:4096
    v_mfma_f32_16x16x32_bf16 v[100:103], v[68:71], v[40:43], v[100:103]
    ds_read_b128 v[32:35], v12 offset:6144
    v_mfma_f32_16x16x32_bf16 v[104:107], v[72:75], v[40:43], v[104:107]
    v_mfma_f32_16x16x32_bf16 v[108:111], v[76:79], v[40:43], v[108:111]
    ds_read_b128 v[52:55], v14 offset:0
    v_mfma_f32_16x16x32_bf16 v[112:115], v[80:83], v[40:43], v[112:115]
    v_mfma_f32_16x16x32_bf16 v[116:119], v[68:71], v[44:47], v[116:119]
    ds_read_b128 v[56:59], v14 offset:2048
    v_mfma_f32_16x16x32_bf16 v[120:123], v[72:75], v[44:47], v[120:123]
    ds_read_b128 v[60:63], v14 offset:4096
    v_mfma_f32_16x16x32_bf16 v[124:127], v[76:79], v[44:47], v[124:127]
    v_mfma_f32_16x16x32_bf16 v[128:131], v[80:83], v[44:47], v[128:131]
    ds_read_b128 v[64:67], v14 offset:6144
    v_mfma_f32_16x16x32_bf16 v[132:135], v[68:71], v[48:51], v[132:135]
    v_mfma_f32_16x16x32_bf16 v[136:139], v[72:75], v[48:51], v[136:139]
    v_mfma_f32_16x16x32_bf16 v[140:143], v[76:79], v[48:51], v[140:143]
    v_mfma_f32_16x16x32_bf16 v[144:147], v[80:83], v[48:51], v[144:147]
    s_waitcnt lgkmcnt(0)
    v_mfma_f32_16x16x32_bf16 v[84:87], v[52:55], v[20:23], v[84:87]
    ds_read_b128 v[36:39], v13 offset:0
    v_mfma_f32_16x16x32_bf16 v[88:91], v[56:59], v[20:23], v[88:91]
    ds_read_b128 v[40:43], v13 offset:2048
    v_mfma_f32_16x16x32_bf16 v[92:95], v[60:63], v[20:23], v[92:95]
    v_mfma_f32_16x16x32_bf16 v[96:99], v[64:67], v[20:23], v[96:99]
    ds_read_b128 v[44:47], v13 offset:4096
    v_mfma_f32_16x16x32_bf16 v[100:103], v[52:55], v[24:27], v[100:103]
    ds_read_b128 v[48:51], v13 offset:6144
    v_mfma_f32_16x16x32_bf16 v[104:107], v[56:59], v[24:27], v[104:107]
    v_mfma_f32_16x16x32_bf16 v[108:111], v[60:63], v[24:27], v[108:111]
    ds_read_b128 v[68:71], v15 offset:0
    v_mfma_f32_16x16x32_bf16 v[112:115], v[64:67], v[24:27], v[112:115]
    v_mfma_f32_16x16x32_bf16 v[116:119], v[52:55], v[28:31], v[116:119]
    ds_read_b128 v[72:75], v15 offset:2048
    v_mfma_f32_16x16x32_bf16 v[120:123], v[56:59], v[28:31], v[120:123]
    ds_read_b128 v[76:79], v15 offset:4096
    v_mfma_f32_16x16x32_bf16 v[124:127], v[60:63], v[28:31], v[124:127]
    v_mfma_f32_16x16x32_bf16 v[128:131], v[64:67], v[28:31], v[128:131]
    ds_read_b128 v[80:83], v15 offset:6144
    v_mfma_f32_16x16x32_bf16 v[132:135], v[52:55], v[32:35], v[132:135]
    v_mfma_f32_16x16x32_bf16 v[136:139], v[56:59], v[32:35], v[136:139]
    v_mfma_f32_16x16x32_bf16 v[140:143], v[60:63], v[32:35], v[140:143]
    v_mfma_f32_16x16x32_bf16 v[144:147], v[64:67], v[32:35], v[144:147]
    s_waitcnt lgkmcnt(0)
    s_barrier
    s_add_u32 s17, s17, 1
    s_cmp_ge_u32 s17, s18
    s_cbranch_scc1 k2_cfin
    v_mfma_f32_16x16x32_bf16 v[84:87], v[68:71], v[36:39], v[84:87]
    ds_read_b128 v[20:23], v16 offset:0
    v_mfma_f32_16x16x32_bf16 v[88:91], v[72:75], v[36:39], v[88:91]
    ds_read_b128 v[24:27], v16 offset:2048
    v_mfma_f32_16x16x32_bf16 v[92:95], v[76:79], v[36:39], v[92:95]
    v_mfma_f32_16x16x32_bf16 v[96:99], v[80:83], v[36:39], v[96:99]
    ds_read_b128 v[28:31], v16 offset:4096
    v_mfma_f32_16x16x32_bf16 v[100:103], v[68:71], v[40:43], v[100:103]
    ds_read_b128 v[32:35], v16 offset:6144
    v_mfma_f32_16x16x32_bf16 v[104:107], v[72:75], v[40:43], v[104:107]
    v_mfma_f32_16x16x32_bf16 v[108:111], v[76:79], v[40:43], v[108:111]
    ds_read_b128 v[52:55], v18 offset:0
    v_mfma_f32_16x16x32_bf16 v[112:115], v[80:83], v[40:43], v[112:115]
    v_mfma_f32_16x16x32_bf16 v[116:119], v[68:71], v[44:47], v[116:119]
    ds_read_b128 v[56:59], v18 offset:2048
    v_mfma_f32_16x16x32_bf16 v[120:123], v[72:75], v[44:47], v[120:123]
    ds_read_b128 v[60:63], v18 offset:4096
    v_mfma_f32_16x16x32_bf16 v[124:127], v[76:79], v[44:47], v[124:127]
    v_mfma_f32_16x16x32_bf16 v[128:131], v[80:83], v[44:47], v[128:131]
    ds_read_b128 v[64:67], v18 offset:6144
    v_mfma_f32_16x16x32_bf16 v[132:135], v[68:71], v[48:51], v[132:135]
    v_mfma_f32_16x16x32_bf16 v[136:139], v[72:75], v[48:51], v[136:139]
    v_mfma_f32_16x16x32_bf16 v[140:143], v[76:79], v[48:51], v[140:143]
    v_mfma_f32_16x16x32_bf16 v[144:147], v[80:83], v[48:51], v[144:147]
    s_waitcnt lgkmcnt(0)
    v_mfma_f32_16x16x32_bf16 v[84:87], v[52:55], v[20:23], v[84:87]
    ds_read_b128 v[36:39], v17 offset:0
    v_mfma_f32_16x16x32_bf16 v[88:91], v[56:59], v[20:23], v[88:91]
    ds_read_b128 v[40:43], v17 offset:2048
    v_mfma_f32_16x16x32_bf16 v[92:95], v[60:63], v[20:23], v[92:95]
    v_mfma_f32_16x16x32_bf16 v[96:99], v[64:67], v[20:23], v[96:99]
    ds_read_b128 v[44:47], v17 offset:4096
    v_mfma_f32_16x16x32_bf16 v[100:103], v[52:55], v[24:27], v[100:103]
    ds_read_b128 v[48:51], v17 offset:6144
    v_mfma_f32_16x16x32_bf16 v[104:107], v[56:59], v[24:27], v[104:107]
    v_mfma_f32_16x16x32_bf16 v[108:111], v[60:63], v[24:27], v[108:111]
    ds_read_b128 v[68:71], v19 offset:0
    v_mfma_f32_16x16x32_bf16 v[112:115], v[64:67], v[24:27], v[112:115]
    v_mfma_f32_16x16x32_bf16 v[116:119], v[52:55], v[28:31], v[116:119]
    ds_read_b128 v[72:75], v19 offset:2048
    v_mfma_f32_16x16x32_bf16 v[120:123], v[56:59], v[28:31], v[120:123]
    ds_read_b128 v[76:79], v19 offset:4096
    v_mfma_f32_16x16x32_bf16 v[124:127], v[60:63], v[28:31], v[124:127]
    v_mfma_f32_16x16x32_bf16 v[128:131], v[64:67], v[28:31], v[128:131]
    ds_read_b128 v[80:83], v19 offset:6144
    v_mfma_f32_16x16x32_bf16 v[132:135], v[52:55], v[32:35], v[132:135]
    v_mfma_f32_16x16x32_bf16 v[136:139], v[56:59], v[32:35], v[136:139]
    v_mfma_f32_16x16x32_bf16 v[140:143], v[60:63], v[32:35], v[140:143]
    v_mfma_f32_16x16x32_bf16 v[144:147], v[64:67], v[32:35], v[144:147]
    s_waitcnt lgkmcnt(0)
    s_barrier
    s_add_u32 s17, s17, 1
    s_cmp_ge_u32 s17, s18
    s_cbranch_scc1 k2_cfin
    v_mfma_f32_16x16x32_bf16 v[84:87], v[68:71], v[36:39], v[84:87]
    ds_read_b128 v[20:23], v4 offset:0
    v_mfma_f32_16x16x32_bf16 v[88:91], v[72:75], v[36:39], v[88:91]
    ds_read_b128 v[24:27], v4 offset:2048
    v_mfma_f32_16x16x32_bf16 v[92:95], v[76:79], v[36:39], v[92:95]
    v_mfma_f32_16x16x32_bf16 v[96:99], v[80:83], v[36:39], v[96:99]
    ds_read_b128 v[28:31], v4 offset:4096
    v_mfma_f32_16x16x32_bf16 v[100:103], v[68:71], v[40:43], v[100:103]
    ds_read_b128 v[32:35], v4 offset:6144
    v_mfma_f32_16x16x32_bf16 v[104:107], v[72:75], v[40:43], v[104:107]
    v_mfma_f32_16x16x32_bf16 v[108:111], v[76:79], v[40:43], v[108:111]
    ds_read_b128 v[52:55], v6 offset:0
    v_mfma_f32_16x16x32_bf16 v[112:115], v[80:83], v[40:43], v[112:115]
    v_mfma_f32_16x16x32_bf16 v[116:119], v[68:71], v[44:47], v[116:119]
    ds_read_b128 v[56:59], v6 offset:2048
    v_mfma_f32_16x16x32_bf16 v[120:123], v[72:75], v[44:47], v[120:123]
    ds_read_b128 v[60:63], v6 offset:4096
    v_mfma_f32_16x16x32_bf16 v[124:127], v[76:79], v[44:47], v[124:127]
    v_mfma_f32_16x16x32_bf16 v[128:131], v[80:83], v[44:47], v[128:131]
    ds_read_b128 v[64:67], v6 offset:6144
    v_mfma_f32_16x16x32_bf16 v[132:135], v[68:71], v[48:51], v[132:135]
    v_mfma_f32_16x16x32_bf16 v[136:139], v[72:75], v[48:51], v[136:139]
    v_mfma_f32_16x16x32_bf16 v[140:143], v[76:79], v[48:51], v[140:143]
    v_mfma_f32_16x16x32_bf16 v[144:147], v[80:83], v[48:51], v[144:147]
    s_waitcnt lgkmcnt(0)
    v_mfma_f32_16x16x32_bf16 v[84:87], v[52:55], v[20:23], v[84:87]
    ds_read_b128 v[36:39], v5 offset:0
    v_mfma_f32_16x16x32_bf16 v[88:91], v[56:59], v[20:23], v[88:91]
    ds_read_b128 v[40:43], v5 offset:2048
    v_mfma_f32_16x16x32_bf16 v[92:95], v[60:63], v[20:23], v[92:95]
    v_mfma_f32_16x16x32_bf16 v[96:99], v[64:67], v[20:23], v[96:99]
    ds_read_b128 v[44:47], v5 offset:4096
    v_mfma_f32_16x16x32_bf16 v[100:103], v[52:55], v[24:27], v[100:103]
    ds_read_b128 v[48:51], v5 offset:6144
    v_mfma_f32_16x16x32_bf16 v[104:107], v[56:59], v[24:27], v[104:107]
    v_mfma_f32_16x16x32_bf16 v[108:111], v[60:63], v[24:27], v[108:111]
    ds_read_b128 v[68:71], v7 offset:0
    v_mfma_f32_16x16x32_bf16 v[112:115], v[64:67], v[24:27], v[112:115]
    v_mfma_f32_16x16x32_bf16 v[116:119], v[52:55], v[28:31], v[116:119]
    ds_read_b128 v[72:75], v7 offset:2048
    v_mfma_f32_16x16x32_bf16 v[120:123], v[56:59], v[28:31], v[120:123]
    ds_read_b128 v[76:79], v7 offset:4096
    v_mfma_f32_16x16x32_bf16 v[124:127], v[60:63], v[28:31], v[124:127]
    v_mfma_f32_16x16x32_bf16 v[128:131], v[64:67], v[28:31], v[128:131]
    ds_read_b128 v[80:83], v7 offset:6144
    v_mfma_f32_16x16x32_bf16 v[132:135], v[52:55], v[32:35], v[132:135]
    v_mfma_f32_16x16x32_bf16 v[136:139], v[56:59], v[32:35], v[136:139]
    v_mfma_f32_16x16x32_bf16 v[140:143], v[60:63], v[32:35], v[140:143]
    v_mfma_f32_16x16x32_bf16 v[144:147], v[64:67], v[32:35], v[144:147]
    s_waitcnt lgkmcnt(0)
    s_barrier
    s_add_u32 s17, s17, 1
    s_cmp_ge_u32 s17, s18
    s_cbranch_scc1 k2_cfin
    s_branch k2_cloop
k2_cfin:
    v_mfma_f32_16x16x32_bf16 v[84:87], v[68:71], v[36:39], v[84:87]
    v_mfma_f32_16x16x32_bf16 v[88:91], v[72:75], v[36:39], v[88:91]
    v_mfma_f32_16x16x32_bf16 v[92:95], v[76:79], v[36:39], v[92:95]
    v_mfma_f32_16x16x32_bf16 v[96:99], v[80:83], v[36:39], v[96:99]
    v_mfma_f32_16x16x32_bf16 v[100:103], v[68:71], v[40:43], v[100:103]
    v_mfma_f32_16x16x32_bf16 v[104:107], v[72:75], v[40:43], v[104:107]
    v_mfma_f32_16x16x32_bf16 v[108:111], v[76:79], v[40:43], v[108:111]
    v_mfma_f32_16x16x32_bf16 v[112:115], v[80:83], v[40:43], v[112:115]
    v_mfma_f32_16x16x32_bf16 v[116:119], v[68:71], v[44:47], v[116:119]
    v_mfma_f32_16x16x32_bf16 v[120:123], v[72:75], v[44:47], v[120:123]
    v_mfma_f32_16x16x32_bf16 v[124:127], v[76:79], v[44:47], v[124:127]
    v_mfma_f32_16x16x32_bf16 v[128:131], v[80:83], v[44:47], v[128:131]
    v_mfma_f32_16x16x32_bf16 v[132:135], v[68:71], v[48:51], v[132:135]
    v_mfma_f32_16x16x32_bf16 v[136:139], v[72:75], v[48:51], v[136:139]
    v_mfma_f32_16x16x32_bf16 v[140:143], v[76:79], v[48:51], v[140:143]
    v_mfma_f32_16x16x32_bf16 v[144:147], v[80:83], v[48:51], v[144:147]
    s_nop 7
    s_nop 7
    s_branch k2_cdone
k2_loader:
    v_lshrrev_b32 v2, 3, v1
    v_and_b32 v3, 7, v1
    v_xor_b32 v3, v3, v2
    v_lshlrev_b32 v3, 4, v3
    s_mul_i32 s24, s16, 32
    s_add_u32 s24, s24, s47
    v_add_u32 v148, s24, v2
    s_mov_b32 s25, 4096
    v_mul_lo_u32 v148, v148, s25
    v_add_u32 v148, v148, v3
    v_add_u32 v4, 0, v148
    v_add_u32 v5, 31744, v148
    v_add_u32 v6, 63488, v148
    v_add_u32 v7, 95232, v148
    s_mul_i32 s24, s16, 32
    s_add_u32 s24, s24, s48
    v_add_u32 v148, s24, v2
    s_mov_b32 s25, 11776
    v_mul_lo_u32 v148, v148, s25
    v_add_u32 v148, v148, v3
    v_add_u32 v8, 0, v148
    v_add_u32 v9, 93184, v148
    v_add_u32 v10, 186368, v148
    v_add_u32 v11, 279552, v148
    s_mul_i32 s22, s16, 4096
    s_mul_i32 s23, s16, 4096
    s_add_u32 s23, s23, 16384
    s_mov_b32 s52, 0
    s_add_u32 s25, s19, s49
    s_cmp_ge_u32 s25, s54
    s_cselect_b32 s24, s51, 0
    s_sub_u32 s25, s25, s24
    s_lshl_b32 s25, s25, 2
    s_add_u32 s25, s25, s46
    s_lshr_b32 s24, s25, 5
    s_and_b32 s20, s25, 31
    s_lshl_b32 s20, s20, 7
    s_cmp_eq_u32 s24, 0
    s_cselect_b64 s[4:5], s[26:27], s[28:29]
    s_cmp_eq_u32 s24, 2
    s_cselect_b64 s[4:5], s[30:31], s[4:5]
    s_lshl_b32 s21, s25, 7
    s_add_u32 s19, s19, 1
    s_add_u32 s24, s22, s52
    s_add_u32 m0, s24, 0
    s_nop 0
    buffer_load_dwordx4 v4, s[4:7], s20 offen lds
    buffer_load_dwordx4 v5, s[4:7], s20 offen offset:1024 lds
    buffer_load_dwordx4 v6, s[4:7], s20 offen offset:2048 lds
    buffer_load_dwordx4 v7, s[4:7], s20 offen offset:3072 lds
    s_add_u32 s24, s23, s52
    s_add_u32 m0, s24, 0
    s_nop 0
    buffer_load_dwordx4 v8, s[8:11], s21 offen lds
    buffer_load_dwordx4 v9, s[8:11], s21 offen offset:1024 lds
    buffer_load_dwordx4 v10, s[8:11], s21 offen offset:2048 lds
    buffer_load_dwordx4 v11, s[8:11], s21 offen offset:3072 lds
    s_add_u32 s52, s52, 32768
    s_cmp_ge_u32 s52, 131072
    s_cselect_b32 s52, 0, s52
    s_add_u32 s25, s19, s49
    s_cmp_ge_u32 s25, s54
    s_cselect_b32 s24, s51, 0
    s_sub_u32 s25, s25, s24
    s_lshl_b32 s25, s25, 2
    s_add_u32 s25, s25, s46
    s_lshr_b32 s24, s25, 5
    s_and_b32 s20, s25, 31
    s_lshl_b32 s20, s20, 7
    s_cmp_eq_u32 s24, 0
    s_cselect_b64 s[4:5], s[26:27], s[28:29]
    s_cmp_eq_u32 s24, 2
    s_cselect_b64 s[4:5], s[30:31], s[4:5]
    s_lshl_b32 s21, s25, 7
    s_add_u32 s19, s19, 1
    s_add_u32 s24, s22, s52
    s_add_u32 m0, s24, 0
    s_nop 0
    buffer_load_dwordx4 v4, s[4:7], s20 offen lds
    buffer_load_dwordx4 v5, s[4:7], s20 offen offset:1024 lds
    buffer_load_dwordx4 v6, s[4:7], s20 offen offset:2048 lds
    buffer_load_dwordx4 v7, s[4:7], s20 offen offset:3072 lds
    s_add_u32 s24, s23, s52
    s_add_u32 m0, s24, 0
    s_nop 0
    buffer_load_dwordx4 v8, s[8:11], s21 offen lds
    buffer_load_dwordx4 v9, s[8:11], s21 offen offset:1024 lds
    buffer_load_dwordx4 v10, s[8:11], s21 offen offset:2048 lds
    buffer_load_dwordx4 v11, s[8:11], s21 offen offset:3072 lds
    s_add_u32 s52, s52, 32768
    s_cmp_ge_u32 s52, 131072
    s_cselect_b32 s52, 0, s52
    s_add_u32 s25, s19, s49
    s_cmp_ge_u32 s25, s54
    s_cselect_b32 s24, s51, 0
    s_sub_u32 s25, s25, s24
    s_lshl_b32 s25, s25, 2
    s_add_u32 s25, s25, s46
    s_lshr_b32 s24, s25, 5
    s_and_b32 s20, s25, 31
    s_lshl_b32 s20, s20, 7
    s_cmp_eq_u32 s24, 0
    s_cselect_b64 s[4:5], s[26:27], s[28:29]
    s_cmp_eq_u32 s24, 2
    s_cselect_b64 s[4:5], s[30:31], s[4:5]
    s_lshl_b32 s21, s25, 7
    s_add_u32 s19, s19, 1
    s_add_u32 s24, s22, s52
    s_add_u32 m0, s24, 0
    s_nop 0
    buffer_load_dwordx4 v4, s[4:7], s20 offen lds
    buffer_load_dwordx4 v5, s[4:7], s20 offen offset:1024 lds
    buffer_load_dwordx4 v6, s[4:7], s20 offen offset:2048 lds
    buffer_load_dwordx4 v7, s[4:7], s20 offen offset:3072 lds
    s_add_u32 s24, s23, s52
    s_add_u32 m0, s24, 0
    s_nop 0
    buffer_load_dwordx4 v8, s[8:11], s21 offen lds
    buffer_load_dwordx4 v9, s[8:11], s21 offen offset:1024 lds
    buffer_load_dwordx4 v10, s[8:11], s21 offen offset:2048 lds
    buffer_load_dwordx4 v11, s[8:11], s21 offen offset:3072 lds
    s_add_u32 s52, s52, 32768
    s_cmp_ge_u32 s52, 131072
    s_cselect_b32 s52, 0, s52
    s_add_u32 s25, s19, s49
    s_cmp_ge_u32 s25, s54
    s_cselect_b32 s24, s51, 0
    s_sub_u32 s25, s25, s24
    s_lshl_b32 s25, s25, 2
    s_add_u32 s25, s25, s46
    s_lshr_b32 s24, s25, 5
    s_and_b32 s20, s25, 31
    s_lshl_b32 s20, s20, 7
    s_cmp_eq_u32 s24, 0
    s_cselect_b64 s[4:5], s[26:27], s[28:29]
    s_cmp_eq_u32 s24, 2
    s_cselect_b64 s[4:5], s[30:31], s[4:5]
    s_lshl_b32 s21, s25, 7
    s_add_u32 s19, s19, 1
    s_add_u32 s24, s22, s52
    s_add_u32 m0, s24, 0
    s_nop 0
    buffer_load_dwordx4 v4, s[4:7], s20 offen lds
    buffer_load_dwordx4 v5, s[4:7], s20 offen offset:1024 lds
    buffer_load_dwordx4 v6, s[4:7], s20 offen offset:2048 lds
    buffer_load_dwordx4 v7, s[4:7], s20 offen offset:3072 lds
    s_add_u32 s24, s23, s52
    s_add_u32 m0, s24, 0
    s_nop 0
    buffer_load_dwordx4 v8, s[8:11], s21 offen lds
    buffer_load_dwordx4 v9, s[8:11], s21 offen offset:1024 lds
    buffer_load_dwordx4 v10, s[8:11], s21 offen offset:2048 lds
    buffer_load_dwordx4 v11, s[8:11], s21 offen offset:3072 lds
    s_add_u32 s52, s52, 32768
    s_cmp_ge_u32 s52, 131072
    s_cselect_b32 s52, 0, s52
    s_waitcnt vmcnt(24)
    s_barrier
    s_waitcnt vmcnt(16)
    s_barrier
    s_sub_u32 s50, s18, 1
k2_lloop:
    s_cmp_ge_u32 s19, s18
    s_cbranch_scc1 k2_lnd
    s_add_u32 s25, s19, s49
    s_cmp_ge_u32 s25, s54
    s_cselect_b32 s24, s51, 0
    s_sub_u32 s25, s25, s24
    s_lshl_b32 s25, s25, 2
    s_add_u32 s25, s25, s46
    s_lshr_b32 s24, s25, 5
    s_and_b32 s20, s25, 31
    s_lshl_b32 s20, s20, 7
    s_cmp_eq_u32 s24, 0
    s_cselect_b64 s[4:5], s[26:27], s[28:29]
    s_cmp_eq_u32 s24, 2
    s_cselect_b64 s[4:5], s[30:31], s[4:5]
    s_lshl_b32 s21, s25, 7
    s_add_u32 s19, s19, 1
    s_add_u32 s24, s22, s52
    s_add_u32 m0, s24, 0
    s_nop 0
    buffer_load_dwordx4 v4, s[4:7], s20 offen lds
    buffer_load_dwordx4 v5, s[4:7], s20 offen offset:1024 lds
    buffer_load_dwordx4 v6, s[4:7], s20 offen offset:2048 lds
    buffer_load_dwordx4 v7, s[4:7], s20 offen offset:3072 lds
    s_add_u32 s24, s23, s52
    s_add_u32 m0, s24, 0
    s_nop 0
    buffer_load_dwordx4 v8, s[8:11], s21 offen lds
    buffer_load_dwordx4 v9, s[8:11], s21 offen offset:1024 lds
    buffer_load_dwordx4 v10, s[8:11], s21 offen offset:2048 lds
    buffer_load_dwordx4 v11, s[8:11], s21 offen offset:3072 lds
    s_add_u32 s52, s52, 32768
    s_cmp_ge_u32 s52, 131072
    s_cselect_b32 s52, 0, s52
    s_waitcnt vmcnt(16)
    s_branch k2_lbar
k2_lnd:
    s_waitcnt vmcnt(0)
k2_lbar:
    s_barrier
    s_add_u32 s17, s17, 1
    s_cmp_lt_u32 s17, s50
    s_cbranch_scc1 k2_lloop
    s_branch k2_ldone
k2_cdone:
    s_lshr_b32 s27, s16, 1
    s_and_b32 s28, s16, 1
    s_mul_i32 s29, s28, 256
    s_mul_i32 s30, s27, 33792
    s_add_u32 s29, s29, s30
    v_and_b32 v2, 15, v1
    v_lshrrev_b32 v3, 4, v1
    v_mul_u32_u24 v2, 528, v2
    v_lshl_add_u32 v2, v3, 4, v2
    v_add_u32 v2, s29, v2
    ds_write_b128 v2, v[84:87] offset:0
    ds_write_b128 v2, v[88:91] offset:64
    ds_write_b128 v2, v[92:95] offset:128
    ds_write_b128 v2, v[96:99] offset:192
    ds_write_b128 v2, v[100:103] offset:8448
    ds_write_b128 v2, v[104:107] offset:8512
    ds_write_b128 v2, v[108:111] offset:8576
    ds_write_b128 v2, v[112:115] offset:8640
    ds_write_b128 v2, v[116:119] offset:16896
    ds_write_b128 v2, v[120:123] offset:16960
    ds_write_b128 v2, v[124:127] offset:17024
    ds_write_b128 v2, v[128:131] offset:17088
    ds_write_b128 v2, v[132:135] offset:25344
    ds_write_b128 v2, v[136:139] offset:25408
    ds_write_b128 v2, v[140:143] offset:25472
    ds_write_b128 v2, v[144:147] offset:25536
    s_waitcnt lgkmcnt(0)
k2_ldone:
    s_barrier
    s_mov_b32 s8, s34
    s_and_b32 s9, s35, 0xffff
    s_mov_b32 s10, 256
    s_mov_b32 s11, 0x00020000
    s_lshr_b32 s24, s47, 5
    s_lshr_b32 s25, s48, 7
    s_add_u32 s24, s24, s25
    s_lshl_b32 s36, s24, 2
    s_add_u32 s12, s32, 16777216
    s_addc_u32 s13, s33, 0
    s_and_b32 s13, s13, 0xffff
    s_mov_b32 s14, 8388608
    s_mov_b32 s15, 0x00020000
    s_lshl_b32 s24, s47, 10
    s_lshl_b32 s25, s48, 1
    s_add_u32 s38, s24, s25
    s_lshl_b32 s31, s46, 21
    s_add_u32 s31, s31, s38
    s_lshl_b32 s37, s46, 5
    v_and_b32 v4, 15, v0
    v_lshrrev_b32 v5, 4, v0
    v_lshlrev_b32 v6, 5, v4
    v_lshlrev_b32 v4, 4, v4
    v_add_u32 v7, 0, v5
    v_add_u32 v8, 32, v7
    v_cmp_le_u32 vcc, s37, v7
    s_nop 1
    v_cndmask_b32 v7, v7, v8, vcc
    v_mul_u32_u24 v8, 528, v7
    v_add_u32 v8, v8, v6
    ds_read_b128 v[16:19], v8
    ds_read_b128 v[20:23], v8 offset:16
    v_lshl_add_u32 v48, v7, 10, v4
    v_add_u32 v7, 32, v5
    v_add_u32 v8, 32, v7
    v_cmp_le_u32 vcc, s37, v7
    s_nop 1
    v_cndmask_b32 v7, v7, v8, vcc
    v_mul_u32_u24 v8, 528, v7
    v_add_u32 v8, v8, v6
    ds_read_b128 v[24:27], v8
    ds_read_b128 v[28:31], v8 offset:16
    v_lshl_add_u32 v49, v7, 10, v4
    v_add_u32 v7, 64, v5
    v_add_u32 v8, 32, v7
    v_cmp_le_u32 vcc, s37, v7
    s_nop 1
    v_cndmask_b32 v7, v7, v8, vcc
    v_mul_u32_u24 v8, 528, v7
    v_add_u32 v8, v8, v6
    ds_read_b128 v[32:35], v8
    ds_read_b128 v[36:39], v8 offset:16
    v_lshl_add_u32 v50, v7, 10, v4
    s_mov_b32 s4, s40
    s_and_b32 s5, s41, 0xffff
    s_mov_b32 s6, 2097152
    s_mov_b32 s7, 0x00020000
    s_mov_b32 s16, s42
    s_and_b32 s17, s43, 0xffff
    s_mov_b32 s18, 1024
    s_mov_b32 s19, 0x00020000
    s_mov_b32 s20, s56
    s_and_b32 s21, s57, 0xffff
    s_mov_b32 s22, 2097152
    s_mov_b32 s23, 0x00020000
    v_add_u32 v7, s37, v5
    v_mul_u32_u24 v8, 528, v7
    v_add_u32 v8, v8, v6
    ds_read_b128 v[64:67], v8
    ds_read_b128 v[68:71], v8 offset:16
    v_lshl_add_u32 v52, v7, 10, v4
    s_waitcnt lgkmcnt(6)
    v_cvt_pk_bf16_f32 v16, v16, v17
    v_cvt_pk_bf16_f32 v17, v18, v19
    v_cvt_pk_bf16_f32 v18, v20, v21
    v_cvt_pk_bf16_f32 v19, v22, v23
    buffer_store_dwordx4 v[16:19], v48, s[12:15], s31 offen sc0 sc1
    s_waitcnt lgkmcnt(4)
    v_cvt_pk_bf16_f32 v24, v24, v25
    v_cvt_pk_bf16_f32 v25, v26, v27
    v_cvt_pk_bf16_f32 v26, v28, v29
    v_cvt_pk_bf16_f32 v27, v30, v31
    buffer_store_dwordx4 v[24:27], v49, s[12:15], s31 offen sc0 sc1
    s_waitcnt lgkmcnt(2)
    v_cvt_pk_bf16_f32 v32, v32, v33
    v_cvt_pk_bf16_f32 v33, v34, v35
    v_cvt_pk_bf16_f32 v34, v36, v37
    v_cvt_pk_bf16_f32 v35, v38, v39
    buffer_store_dwordx4 v[32:35], v50, s[12:15], s31 offen sc0 sc1
    s_lshl_b32 s30, s48, 1
    v_add_u32 v9, s30, v4
    buffer_load_dwordx4 v[56:59], v9, s[16:19], 0 offen
    buffer_load_dwordx4 v[60:63], v52, s[4:7], s38 offen
    s_waitcnt vmcnt(2)
    s_barrier
    v_cmp_eq_u32 vcc, 0, v0
    s_and_saveexec_b64 s[24:25], vcc
    s_cbranch_execz k2_pl2
    v_mov_b32 v10, 1
    v_mov_b32 v11, s36
    buffer_atomic_add v10, v11, s[8:11], 0 offen sc1
k2_poll:
    buffer_load_dword v10, v11, s[8:11], 0 offen sc0 sc1
    s_waitcnt vmcnt(0)
    s_nop 0
    v_readfirstlane_b32 s30, v10
    s_cmp_ge_u32 s30, 4
    s_cbranch_scc1 k2_pl2
    s_sleep 1
    s_branch k2_poll
k2_pl2:
    s_mov_b64 exec, s[24:25]
    s_barrier
    s_add_u32 s24, s46, 1
    s_and_b32 s24, s24, 3
    s_lshl_b32 s24, s24, 21
    s_add_u32 s24, s24, s38
    buffer_load_dwordx4 v[72:75], v52, s[12:15], s24 offen sc0 sc1
    s_add_u32 s24, s46, 2
    s_and_b32 s24, s24, 3
    s_lshl_b32 s24, s24, 21
    s_add_u32 s24, s24, s38
    buffer_load_dwordx4 v[76:79], v52, s[12:15], s24 offen sc0 sc1
    s_add_u32 s24, s46, 3
    s_and_b32 s24, s24, 3
    s_lshl_b32 s24, s24, 21
    s_add_u32 s24, s24, s38
    buffer_load_dwordx4 v[80:83], v52, s[12:15], s24 offen sc0 sc1
    s_waitcnt vmcnt(3) lgkmcnt(0)
    v_lshlrev_b32 v12, 16, v56
    v_and_b32 v13, 0xffff0000, v56
    v_add_f32 v64, v64, v12
    v_add_f32 v65, v65, v13
    v_lshlrev_b32 v12, 16, v57
    v_and_b32 v13, 0xffff0000, v57
    v_add_f32 v66, v66, v12
    v_add_f32 v67, v67, v13
    v_lshlrev_b32 v12, 16, v58
    v_and_b32 v13, 0xffff0000, v58
    v_add_f32 v68, v68, v12
    v_add_f32 v69, v69, v13
    v_lshlrev_b32 v12, 16, v59
    v_and_b32 v13, 0xffff0000, v59
    v_add_f32 v70, v70, v12
    v_add_f32 v71, v71, v13
    v_lshlrev_b32 v12, 16, v60
    v_and_b32 v13, 0xffff0000, v60
    v_add_f32 v64, v64, v12
    v_add_f32 v65, v65, v13
    v_lshlrev_b32 v12, 16, v61
    v_and_b32 v13, 0xffff0000, v61
    v_add_f32 v66, v66, v12
    v_add_f32 v67, v67, v13
    v_lshlrev_b32 v12, 16, v62
    v_and_b32 v13, 0xffff0000, v62
    v_add_f32 v68, v68, v12
    v_add_f32 v69, v69, v13
    v_lshlrev_b32 v12, 16, v63
    v_and_b32 v13, 0xffff0000, v63
    v_add_f32 v70, v70, v12
    v_add_f32 v71, v71, v13
    s_waitcnt vmcnt(0)
    v_lshlrev_b32 v12, 16, v72
    v_and_b32 v13, 0xffff0000, v72
    v_add_f32 v64, v64, v12
    v_add_f32 v65, v65, v13
    v_lshlrev_b32 v12, 16, v73
    v_and_b32 v13, 0xffff0000, v73
    v_add_f32 v66, v66, v12
    v_add_f32 v67, v67, v13
    v_lshlrev_b32 v12, 16, v74
    v_and_b32 v13, 0xffff0000, v74
    v_add_f32 v68, v68, v12
    v_add_f32 v69, v69, v13
    v_lshlrev_b32 v12, 16, v75
    v_and_b32 v13, 0xffff0000, v75
    v_add_f32 v70, v70, v12
    v_add_f32 v71, v71, v13
    v_lshlrev_b32 v12, 16, v76
    v_and_b32 v13, 0xffff0000, v76
    v_add_f32 v64, v64, v12
    v_add_f32 v65, v65, v13
    v_lshlrev_b32 v12, 16, v77
    v_and_b32 v13, 0xffff0000, v77
    v_add_f32 v66, v66, v12
    v_add_f32 v67, v67, v13
    v_lshlrev_b32 v12, 16, v78
    v_and_b32 v13, 0xffff0000, v78
    v_add_f32 v68, v68, v12
    v_add_f32 v69, v69, v13
    v_lshlrev_b32 v12, 16, v79
    v_and_b32 v13, 0xffff0000, v79
    v_add_f32 v70, v70, v12
    v_add_f32 v71, v71, v13
    v_lshlrev_b32 v12, 16, v80
    v_and_b32 v13, 0xffff0000, v80
    v_add_f32 v64, v64, v12
    v_add_f32 v65, v65, v13
    v_lshlrev_b32 v12, 16, v81
    v_and_b32 v13, 0xffff0000, v81
    v_add_f32 v66, v66, v12
    v_add_f32 v67, v67, v13
    v_lshlrev_b32 v12, 16, v82
    v_and_b32 v13, 0xffff0000, v82
    v_add_f32 v68, v68, v12
    v_add_f32 v69, v69, v13
    v_lshlrev_b32 v12, 16, v83
    v_and_b32 v13, 0xffff0000, v83
    v_add_f32 v70, v70, v12
    v_add_f32 v71, v71, v13
    v_cvt_pk_bf16_f32 v16, v64, v65
    v_cvt_pk_bf16_f32 v17, v66, v67
    v_cvt_pk_bf16_f32 v18, v68, v69
    v_cvt_pk_bf16_f32 v19, v70, v71
    buffer_store_dwordx4 v[16:19], v52, s[20:23], s38 offen
L_k2_end:
    s_endpgm
.section .rodata,"a"
.p2align 6
.amdhsa_kernel gemm1_kernel
  .amdhsa_next_free_vgpr 256
  .amdhsa_next_free_sgpr 96
  .amdhsa_accum_offset 256
  .amdhsa_group_segment_fixed_size 0
  .amdhsa_kernarg_size 104
  .amdhsa_user_sgpr_count 2
  .amdhsa_user_sgpr_kernarg_segment_ptr 1
  .amdhsa_system_sgpr_workgroup_id_x 1
.end_amdhsa_kernel
.p2align 6
.amdhsa_kernel gemm2_kernel
  .amdhsa_next_free_vgpr 160
  .amdhsa_next_free_sgpr 96
  .amdhsa_accum_offset 160
  .amdhsa_group_segment_fixed_size 0
  .amdhsa_kernarg_size 104
  .amdhsa_user_sgpr_count 2
  .amdhsa_user_sgpr_kernarg_segment_ptr 1
  .amdhsa_system_sgpr_workgroup_id_x 1
.end_amdhsa_kernel
```
